```python
import torch

def _softmax(x, axis=-1):
    return torch.softmax(x, dim=axis)
def _gelu(x):
    return torch.nn.functional.gelu(x, approximate="tanh")
def _silu(x):
    return torch.nn.functional.silu(x)
def _sigmoid(x):
    return torch.sigmoid(x)
def _layernorm(x, axis=-1, eps=1e-5):
    m = x.mean(dim=axis, keepdim=True)
    v = x.var(dim=axis, keepdim=True, unbiased=False)
    return (x - m) / torch.sqrt(v + eps)
def _scatter_add(tgt, idx, src, axis=0):
    return tgt.clone().index_add_(axis, idx, src)
def _segment_sum(src, seg, n):
    out = torch.zeros((n,) + src.shape[1:], dtype=src.dtype)
    return out.index_add_(0, seg, src)
def _pad(x, pw):
    flat = tuple(v for pair in reversed(pw) for v in pair)
    return torch.nn.functional.pad(x, flat)

kernel_name = 'gated_mix__mha_block__glu_gated_geglu__prompt'

def setup_inputs():

    _w = (lambda a: (lambda t: t.to(torch.bfloat16) if t.is_floating_point() else t)(torch.as_tensor(a)))
    def _A_setup():
        B, S, D, H = 1, 2048, 448, 16
        return {
            "x": _w((lambda *s: torch.randn(*s, dtype=torch.bfloat16) * 0.05)(B, S, D)),
            "wqkv": _w((lambda *s: torch.randn(*s, dtype=torch.bfloat16) * 0.8)(D, 3 * D)),
            "wo": _w((lambda *s: torch.randn(*s, dtype=torch.bfloat16) * 0.05)(D, D)),
        }
    _A_in = _A_setup()

    def _B_setup():
        B, S, Dm, Df = 1, 2048, 448, 1792
        return {
            "x": _w((lambda *s: torch.randn(*s, dtype=torch.bfloat16) * 0.05)(B, S, Dm)),
            "w_gate": _w((lambda *s: torch.randn(*s, dtype=torch.bfloat16) * 1.6)(Dm, Df) * (Dm ** -0.5)),
            "w_up": _w((lambda *s: torch.randn(*s, dtype=torch.bfloat16) * 1.6)(Dm, Df) * (Dm ** -0.5)),
            "w_down": _w((lambda *s: torch.randn(*s, dtype=torch.bfloat16) * 1.6)(Df, Dm) * (Df ** -0.5)),
        }
    _B_in = _B_setup()

    return {
        "A_x": _A_in["x"],
        "A_wqkv": _A_in["wqkv"],
        "A_wo": _A_in["wo"],
        "B_x": _B_in["x"],
        "B_w_gate": _B_in["w_gate"],
        "B_w_up": _B_in["w_up"],
        "B_w_down": _B_in["w_down"],
        "gate_w": _w((lambda *s: torch.randn(*s, dtype=torch.bfloat16) * 0.05)(448) * 16.0),
    }

def reference(A_x, A_wqkv, A_wo, B_x, B_w_gate, B_w_up, B_w_down, gate_w):
    def _A_ref(x, wqkv, wo):
        B, S, D = x.shape
        H = 16
        Dh = D // H
        qkv = (lambda x, *d: x.permute(*d))((x @ wqkv).reshape(B, S, 3, H, Dh), 2, 0, 3, 1, 4)
        q, k, v = qkv[0], qkv[1], qkv[2]
        scores = torch.einsum("bhqd,bhkd->bhqk", q, k) * (Dh ** -0.5)
        p = _softmax(scores, axis=-1)
        o = torch.einsum("bhqk,bhkd->bhqd", p, v)
        return (lambda x, *d: x.permute(*d))(o, 0, 2, 1, 3).reshape(B, S, D) @ wo

    def _B_ref(x, w_gate, w_up, w_down):
        g = torch.einsum("bsd,df->bsf", x, w_gate)
        u = torch.einsum("bsd,df->bsf", x, w_up)
        h = _gelu(g) * u
        return torch.einsum("bsf,fd->bsd", h, w_down)

    x = A_x
    g = _sigmoid((x * gate_w).sum(-1, keepdims=True))
    a = _A_ref(x, A_wqkv, A_wo)
    b = _B_ref(x, B_w_gate, B_w_up, B_w_down)
    return g * a + (1 - g) * b
```

```asm
; @launch grid=(256,1,1) block=(512,1,1) lds=163840
.amdgcn_target "amdgcn-amd-amdhsa--gfx950"
.text
.globl gated_mix__mha_block__glu_gated_geglu__prompt_kernel
.p2align 8
.type gated_mix__mha_block__glu_gated_geglu__prompt_kernel,@function
gated_mix__mha_block__glu_gated_geglu__prompt_kernel:
    s_cmp_ge_u32 s2, 256
    s_cbranch_scc1 Lend
    s_load_dwordx16 s[16:31], s[0:1], 0
    s_load_dwordx4 s[32:35], s[0:1], 64
    s_load_dwordx2 s[36:37], s[0:1], 80
    v_lshrrev_b32 v1, 6, v0
    v_and_b32 v251, 63, v0
    v_readfirstlane_b32 s3, v1
    v_lshlrev_b32 v250, 4, v251
    v_mov_b32 v252, 0
    s_and_b32 s11, s2, 7
    s_lshr_b32 s12, s2, 3
    s_and_b32 s13, s11, 1
    s_lshl_b32 s13, s13, 3
    s_and_b32 s14, s12, 7
    s_add_u32 s4, s13, s14
    s_lshr_b32 s13, s11, 1
    s_lshr_b32 s38, s12, 3
    s_mul_i32 s15, s13, 3
    s_add_u32 s15, s15, s38
    s_add_u32 s13, s13, 12
    s_cmp_eq_u32 s38, 3
    s_cselect_b32 s5, s13, s15
    s_cselect_b32 s39, 1, 0
    s_lshl_b32 s38, s38, 1
    s_add_u32 s38, s38, s14
    s_sub_u32 s13, s38, 7
    s_cselect_b32 s82, s38, s13
    s_and_b32 s12, s3, 3
    v_lshrrev_b32 v16, 3, v251
    v_and_b32 v17, 7, v251
    s_cmp_lt_u32 s3, 4
    s_cbranch_scc1 Lsetup_lo
    s_setprio 3
    s_lshl_b32 s11, s4, 7
    s_lshl_b32 s13, s12, 5
    s_add_u32 s11, s11, s13
    v_add_u32 v27, s11, v16
    v_mul_u32_u24 v27, 896, v27
    v_lshrrev_b32 v28, 1, v16
    v_xor_b32 v28, v28, v17
    v_lshl_add_u32 v11, v28, 4, v27
    v_xor_b32 v28, 4, v28
    v_lshl_add_u32 v12, v28, 4, v27
    v_add_u32 v12, 7168, v12
    s_lshl_b32 s14, s12, 12
    s_lshl_b32 s83, s82, 7
    s_mov_b32 s42, 0x1c0000
    s_mov_b32 s43, 0x20000
    s_lshl_b32 s15, s12, 10
    v_bfe_u32 v25, v16, 1, 1
    v_lshlrev_b32 v25, 2, v25
    v_xor_b32 v25, v25, v17
    v_lshlrev_b32 v25, 4, v25
    s_lshl_b32 s38, s12, 3
    v_add_u32 v26, s38, v16
    s_lshl_b32 s76, s12, 11
    v_mul_u32_u24 v28, 2688, v26
    s_mul_i32 s38, s5, 112
    v_add3_u32 v13, v28, v25, s38
    s_mul_i32 s74, s82, 172032
    s_mov_b32 s46, 0x126000
    s_mov_b32 s47, 0x20000
    s_cmp_eq_u32 s39, 1
    s_waitcnt lgkmcnt(0)
    s_mov_b64 s[40:41], s[16:17]
    s_mov_b64 s[44:45], s[18:19]
    s_cbranch_scc1 Lload_s
    s_lshl_b32 s12, s83, 7
    s_add_u32 s12, s12, s14
    s_add_u32 s13, s83, 14336
    s_add_u32 m0, s12, 0
    s_nop 0
    buffer_load_dwordx4 v11, s[40:43], s83 offen lds
    s_add_u32 m0, s12, 1024
    s_nop 0
    buffer_load_dwordx4 v12, s[40:43], s83 offen lds
    s_add_u32 m0, s12, 2048
    s_nop 0
    buffer_load_dwordx4 v11, s[40:43], s13 offen lds
    s_add_u32 m0, s12, 3072
    s_nop 0
    buffer_load_dwordx4 v12, s[40:43], s13 offen lds
    s_add_u32 s83, s83, 128
    s_cmp_eq_u32 s83, 896
    s_cselect_b32 s83, 0, s83
    s_add_u32 m0, s15, 147456
    s_nop 0
    buffer_load_dwordx4 v13, s[44:47], s74 offen lds
    s_add_u32 s74, s74, 86016
    s_add_u32 m0, s15, 151552
    s_nop 0
    buffer_load_dwordx4 v13, s[44:47], s74 offen lds
    s_add_u32 s74, s74, 86016
    s_cmp_eq_u32 s74, 1204224
    s_cselect_b32 s74, 0, s74
    s_and_b32 s86, s3, 1
    s_bfe_u32 s87, s3, 0x10001
    s_lshl_b32 s11, s5, 1
    s_add_u32 s38, s5, 12
    s_cmp_eq_u32 s39, 1
    s_cselect_b32 s85, s38, s11
    v_mul_u32_u24 v27, 3584, v26
    s_lshl_b32 s11, s85, 7
    v_add3_u32 v236, v27, v25, s11
    v_xor_b32 v237, 32, v236
    s_mul_i32 s75, s82, 229376
    s_mov_b32 s52, s36
    s_mov_b32 s53, s37
    s_mov_b32 s54, 0x1000000
    s_mov_b32 s55, 0x20000
    s_mov_b32 s48, s24
    s_mov_b32 s49, s25
    s_mov_b32 s50, 0x188000
    s_mov_b32 s51, 0x20000
    s_mov_b32 s60, s26
    s_mov_b32 s61, s27
    s_mov_b32 s62, 0x188000
    s_mov_b32 s63, 0x20000
    s_mov_b32 s68, s34
    s_mov_b32 s69, s35
    s_mov_b32 s70, 0x100
    s_mov_b32 s71, 0x20000
    v_mov_b32 v32, 16384000
    s_lshl_b32 s38, s2, 3
    s_add_u32 s38, s38, s3
    s_cmp_lg_u32 s38, 7
    s_cbranch_scc1 Lnonce_1
    buffer_load_dword v33, v32, s[52:55], 0 offen sc1
Lnonce_1:
    s_lshl_b32 s12, s83, 7
    s_add_u32 s12, s12, s14
    s_add_u32 s13, s83, 14336
    s_add_u32 m0, s12, 0
    s_nop 0
    buffer_load_dwordx4 v11, s[40:43], s83 offen lds
    s_add_u32 m0, s12, 1024
    s_nop 0
    buffer_load_dwordx4 v12, s[40:43], s83 offen lds
    s_add_u32 m0, s12, 2048
    s_nop 0
    buffer_load_dwordx4 v11, s[40:43], s13 offen lds
    s_add_u32 m0, s12, 3072
    s_nop 0
    buffer_load_dwordx4 v12, s[40:43], s13 offen lds
    s_add_u32 s83, s83, 128
    s_cmp_eq_u32 s83, 896
    s_cselect_b32 s83, 0, s83
    s_add_u32 m0, s15, 155648
    s_nop 0
    buffer_load_dwordx4 v13, s[44:47], s74 offen lds
    s_add_u32 s74, s74, 86016
    s_add_u32 m0, s15, 114688
    s_nop 0
    buffer_load_dwordx4 v13, s[44:47], s74 offen lds
    s_add_u32 s74, s74, 86016
    s_cmp_eq_u32 s74, 1204224
    s_cselect_b32 s74, 0, s74
    s_lshl_b32 s12, s83, 7
    s_add_u32 s12, s12, s14
    s_add_u32 s13, s83, 14336
    s_add_u32 m0, s12, 0
    s_nop 0
    buffer_load_dwordx4 v11, s[40:43], s83 offen lds
    s_add_u32 m0, s12, 1024
    s_nop 0
    buffer_load_dwordx4 v12, s[40:43], s83 offen lds
    s_add_u32 m0, s12, 2048
    s_nop 0
    buffer_load_dwordx4 v11, s[40:43], s13 offen lds
    s_add_u32 m0, s12, 3072
    s_nop 0
    buffer_load_dwordx4 v12, s[40:43], s13 offen lds
    s_add_u32 s83, s83, 128
    s_cmp_eq_u32 s83, 896
    s_cselect_b32 s83, 0, s83
    s_add_u32 m0, s15, 118784
    s_nop 0
    buffer_load_dwordx4 v13, s[44:47], s74 offen lds
    s_add_u32 s74, s74, 86016
    s_add_u32 m0, s15, 122880
    s_nop 0
    buffer_load_dwordx4 v13, s[44:47], s74 offen lds
    s_add_u32 s74, s74, 86016
    s_cmp_eq_u32 s74, 1204224
    s_cselect_b32 s74, 0, s74
    s_waitcnt vmcnt(12)
    s_barrier
    s_lshl_b32 s12, s83, 7
    s_add_u32 s12, s12, s14
    s_add_u32 s13, s83, 14336
    s_add_u32 m0, s12, 0
    s_nop 0
    buffer_load_dwordx4 v11, s[40:43], s83 offen lds
    s_add_u32 m0, s12, 1024
    s_nop 0
    buffer_load_dwordx4 v12, s[40:43], s83 offen lds
    s_add_u32 m0, s12, 2048
    s_nop 0
    buffer_load_dwordx4 v11, s[40:43], s13 offen lds
    s_add_u32 m0, s12, 3072
    s_nop 0
    buffer_load_dwordx4 v12, s[40:43], s13 offen lds
    s_add_u32 s83, s83, 128
    s_cmp_eq_u32 s83, 896
    s_cselect_b32 s83, 0, s83
    s_add_u32 m0, s15, 126976
    s_nop 0
    buffer_load_dwordx4 v13, s[44:47], s74 offen lds
    s_add_u32 s74, s74, 86016
    s_add_u32 m0, s15, 131072
    s_nop 0
    buffer_load_dwordx4 v13, s[44:47], s74 offen lds
    s_add_u32 s74, s74, 86016
    s_cmp_eq_u32 s74, 1204224
    s_cselect_b32 s74, 0, s74
    s_waitcnt vmcnt(12)
    s_barrier
    s_lshl_b32 s38, s2, 3
    s_add_u32 s38, s38, s3
    s_cmp_lg_u32 s38, 7
    s_cbranch_scc1 Lnonce_2
    s_getreg_b32 s38, hwreg(HW_REG_XCC_ID, 0, 1)
    s_lshl_b32 s38, s38, 1
    s_or_b32 s38, s38, 1
    v_add_u32 v33, 0x10000, v33
    v_and_b32 v33, -4, v33
    v_or_b32 v33, s38, v33
    s_mov_b64 exec, 1
    buffer_store_dword v33, v32, s[52:55], 0 offen sc1
    buffer_store_dword v33, v252, s[68:71], 0 offen sc1
    s_mov_b64 exec, -1
Lnonce_2:
    s_lshl_b32 s12, s83, 7
    s_add_u32 s12, s12, s14
    s_add_u32 s13, s83, 14336
    s_add_u32 m0, s12, 0
    s_nop 0
    buffer_load_dwordx4 v11, s[40:43], s83 offen lds
    s_add_u32 m0, s12, 1024
    s_nop 0
    buffer_load_dwordx4 v12, s[40:43], s83 offen lds
    s_add_u32 m0, s12, 2048
    s_nop 0
    buffer_load_dwordx4 v11, s[40:43], s13 offen lds
    s_add_u32 m0, s12, 3072
    s_nop 0
    buffer_load_dwordx4 v12, s[40:43], s13 offen lds
    s_add_u32 s83, s83, 128
    s_cmp_eq_u32 s83, 896
    s_cselect_b32 s83, 0, s83
    s_add_u32 m0, s15, 135168
    s_nop 0
    buffer_load_dwordx4 v13, s[44:47], s74 offen lds
    s_add_u32 s74, s74, 86016
    s_add_u32 m0, s15, 139264
    s_nop 0
    buffer_load_dwordx4 v13, s[44:47], s74 offen lds
    s_add_u32 s74, s74, 86016
    s_cmp_eq_u32 s74, 1204224
    s_cselect_b32 s74, 0, s74
    s_waitcnt vmcnt(12)
    s_barrier
    s_lshl_b32 s12, s83, 7
    s_add_u32 s12, s12, s14
    s_add_u32 s13, s83, 14336
    s_add_u32 m0, s12, 0
    s_nop 0
    buffer_load_dwordx4 v11, s[40:43], s83 offen lds
    s_add_u32 m0, s12, 1024
    s_nop 0
    buffer_load_dwordx4 v12, s[40:43], s83 offen lds
    s_add_u32 m0, s12, 2048
    s_nop 0
    buffer_load_dwordx4 v11, s[40:43], s13 offen lds
    s_add_u32 m0, s12, 3072
    s_nop 0
    buffer_load_dwordx4 v12, s[40:43], s13 offen lds
    s_add_u32 s83, s83, 128
    s_cmp_eq_u32 s83, 896
    s_cselect_b32 s83, 0, s83
    s_add_u32 m0, s15, 143360
    s_nop 0
    buffer_load_dwordx4 v13, s[44:47], s74 offen lds
    s_add_u32 s74, s74, 86016
    s_add_u32 m0, s15, 147456
    s_nop 0
    buffer_load_dwordx4 v13, s[44:47], s74 offen lds
    s_add_u32 s74, s74, 86016
    s_cmp_eq_u32 s74, 1204224
    s_cselect_b32 s74, 0, s74
    s_add_u32 m0, s15, 151552
    s_nop 0
    buffer_load_dwordx4 v13, s[44:47], s74 offen lds
    s_add_u32 s74, s74, 86016
    s_add_u32 m0, s15, 155648
    s_nop 0
    buffer_load_dwordx4 v13, s[44:47], s74 offen lds
    s_add_u32 s74, s74, 86016
    s_cmp_eq_u32 s74, 1204224
    s_cselect_b32 s74, 0, s74
    s_waitcnt vmcnt(14)
    s_barrier
    s_lshl_b32 s12, s83, 7
    s_add_u32 s12, s12, s14
    s_add_u32 s13, s83, 14336
    s_add_u32 m0, s12, 0
    s_nop 0
    buffer_load_dwordx4 v11, s[40:43], s83 offen lds
    s_add_u32 m0, s12, 1024
    s_nop 0
    buffer_load_dwordx4 v12, s[40:43], s83 offen lds
    s_add_u32 m0, s12, 2048
    s_nop 0
    buffer_load_dwordx4 v11, s[40:43], s13 offen lds
    s_add_u32 m0, s12, 3072
    s_nop 0
    buffer_load_dwordx4 v12, s[40:43], s13 offen lds
    s_add_u32 s83, s83, 128
    s_cmp_eq_u32 s83, 896
    s_cselect_b32 s83, 0, s83
    s_and_b32 s11, s2, 7
    s_lshr_b32 s12, s2, 3
    s_lshl_b32 s13, s11, 1
    s_lshr_b32 s38, s12, 4
    s_add_u32 s6, s13, s38
    s_and_b32 s7, s12, 15
    s_mov_b32 s98, 0xffff0000
    s_mov_b32 s99, 0xffff0000
    v_bfe_u32 v18, v251, 2, 2
    v_and_b32 v19, 3, v251
    v_lshlrev_b32 v19, 3, v19
    v_lshrrev_b32 v20, 5, v251
    v_and_b32 v21, 31, v251
    v_lshl_add_u32 v22, v20, 3, v18
    v_lshlrev_b32 v22, 7, v22
    v_lshrrev_b32 v23, 1, v18
    v_lshlrev_b32 v23, 6, v23
    v_bfe_u32 v24, v21, 1, 3
    v_xor_b32 v24, v24, v20
    v_lshlrev_b32 v24, 4, v24
    s_lshl_b32 s11, s86, 13
    v_lshl_add_u32 v232, v21, 7, v24
    v_add_u32 v232, s11, v232
    s_lshl_b32 s81, s82, 14
    s_lshl_b32 s11, s87, 6
    s_add_u32 s11, s11, 0
    s_xor_b32 s12, s11, 4128
    v_mov_b32 v27, s11
    v_mov_b32 v28, s12
    v_cndmask_b32 v27, v27, v28, s[98:99]
    v_add_u32 v27, v27, v19
    v_xor_b32 v27, v27, v23
    v_add_u32 v221, v27, v22
    s_lshl_b32 s11, s87, 6
    s_add_u32 s11, s11, 32
    s_xor_b32 s12, s11, 4128
    v_mov_b32 v27, s11
    v_mov_b32 v28, s12
    v_cndmask_b32 v27, v27, v28, s[98:99]
    v_add_u32 v27, v27, v19
    v_xor_b32 v27, v27, v23
    v_add_u32 v222, v27, v22
    s_mov_b32 s94, 0xbdd2d3e8
    s_mov_b32 s95, 0xc0135761
    v_mov_b32 v235, s95
    v_mov_b32 v32, 0
    v_mov_b32 v33, 0
    v_mov_b32 v34, 0
    v_mov_b32 v35, 0
    v_mov_b32 v36, 0
    v_mov_b32 v37, 0
    v_mov_b32 v38, 0
    s_waitcnt vmcnt(12)
    s_barrier
    s_add_u32 m0, s15, 114688
    s_nop 0
    buffer_load_dwordx4 v236, s[48:51], s75 offen lds
    s_add_u32 m0, s15, 118784
    s_nop 0
    buffer_load_dwordx4 v237, s[60:63], s75 offen lds
    s_add_u32 s75, s75, 114688
    s_cmp_eq_u32 s75, 1605632
    s_cselect_b32 s75, 0, s75
    s_add_u32 m0, s15, 122880
    s_nop 0
    buffer_load_dwordx4 v236, s[48:51], s75 offen lds
    s_add_u32 m0, s15, 126976
    s_nop 0
    buffer_load_dwordx4 v237, s[60:63], s75 offen lds
    s_add_u32 s75, s75, 114688
    s_cmp_eq_u32 s75, 1605632
    s_cselect_b32 s75, 0, s75
    s_lshl_b32 s38, s2, 12
    s_add_u32 s38, s38, s15
    s_lshr_b32 s38, s38, 10
    s_mul_i32 s38, s38, 2688
    s_sub_u32 s78, s38, 1605632
    s_cselect_b32 s38, s38, s78
    s_cselect_b32 s64, s28, s20
    s_cselect_b32 s65, s29, s21
    s_mov_b32 s78, 401408
    s_cselect_b32 s66, 1605632, s78
    s_mov_b32 s67, 0x20000
    v_min_u32 v239, 20, v251
    v_lshlrev_b32 v239, 7, v239
    buffer_load_dword v238, v239, s[64:67], s38 offen
    s_lshr_b32 s38, s2, 3
    s_lshl_b32 s38, s38, 1
    s_add_u32 s38, s38, s87
    s_mul_i32 s38, s38, 10
    v_min_u32 v239, 9, v251
    v_add_u32 v239, s38, v239
    v_mul_u32_u24 v239, 3584, v239
    s_bfe_u32 s38, s2, 0x20001
    s_lshl_b32 s38, s38, 7
    s_add_u32 s38, s38, 3072
    s_bitcmp1_b32 s3, 0
    s_cselect_b32 s64, s26, s24
    s_cselect_b32 s65, s27, s25
    s_mov_b32 s66, 1605632
    s_mov_b32 s67, 0x20000
    buffer_load_dword v238, v239, s[64:67], s38 offen
    s_mul_i32 s38, s87, 224
    s_bfe_u32 s78, s2, 0x30003
    s_add_u32 s38, s38, s78
    v_min_u32 v239, 27, v251
    v_lshl_add_u32 v239, v239, 3, s38
    v_mul_u32_u24 v239, 3584, v239
    s_add_u32 s38, s85, 1
    s_lshl_b32 s38, s38, 7
    s_bitcmp1_b32 s3, 0
    s_cselect_b32 s64, s26, s24
    s_cselect_b32 s65, s27, s25
    s_mov_b32 s66, 1605632
    s_mov_b32 s67, 0x20000
    buffer_load_dword v238, v239, s[64:67], s38 offen
    v_mov_b32 v39, 0
    v_mov_b32 v40, 0
    v_mov_b32 v41, 0
    v_mov_b32 v42, 0
    v_mov_b32 v43, 0
    v_mov_b32 v44, 0
    v_mov_b32 v45, 0
    v_mov_b32 v46, 0
    v_mov_b32 v47, 0
    v_mov_b32 v48, 0
    v_mov_b32 v49, 0
    v_mov_b32 v50, 0
    v_mov_b32 v51, 0
    v_mov_b32 v52, 0
    v_mov_b32 v53, 0
    v_mov_b32 v54, 0
    v_mov_b32 v55, 0
    v_mov_b32 v56, 0
    v_mov_b32 v57, 0
    v_mov_b32 v58, 0
    v_mov_b32 v59, 0
    v_mov_b32 v60, 0
    v_mov_b32 v61, 0
    v_mov_b32 v62, 0
    v_mov_b32 v63, 0
    v_mov_b32 v64, 0
    v_mov_b32 v65, 0
    v_mov_b32 v66, 0
    v_mov_b32 v67, 0
    v_mov_b32 v68, 0
    v_mov_b32 v69, 0
    v_mov_b32 v70, 0
    v_mov_b32 v71, 0
    v_mov_b32 v72, 0
    v_mov_b32 v73, 0
    v_mov_b32 v74, 0
    v_mov_b32 v75, 0
    v_mov_b32 v76, 0
    v_mov_b32 v77, 0
    v_mov_b32 v78, 0
    v_mov_b32 v79, 0
    v_mov_b32 v80, 0
    v_mov_b32 v81, 0
    v_mov_b32 v82, 0
    v_mov_b32 v83, 0
    v_mov_b32 v84, 0
    v_mov_b32 v85, 0
    v_mov_b32 v86, 0
    v_mov_b32 v87, 0
    v_mov_b32 v88, 0
    v_mov_b32 v89, 0
    s_waitcnt vmcnt(13)
    s_barrier
    v_mov_b32 v90, 0
    v_mov_b32 v91, 0
    v_mov_b32 v92, 0
    v_mov_b32 v93, 0
    v_mov_b32 v94, 0
    v_mov_b32 v95, 0
    v_mov_b32 v96, 0
    v_mov_b32 v97, 0
    v_mov_b32 v98, 0
    v_mov_b32 v99, 0
    v_mov_b32 v100, 0
    v_mov_b32 v101, 0
    v_mov_b32 v102, 0
    v_mov_b32 v103, 0
    v_mov_b32 v104, 0
    v_mov_b32 v105, 0
    v_mov_b32 v106, 0
    v_mov_b32 v107, 0
    v_mov_b32 v108, 0
    v_mov_b32 v109, 0
    v_mov_b32 v110, 0
    v_mov_b32 v111, 0
    v_mov_b32 v112, 0
    v_mov_b32 v113, 0
    v_mov_b32 v114, 0
    v_mov_b32 v115, 0
    v_mov_b32 v116, 0
    v_mov_b32 v117, 0
    v_mov_b32 v118, 0
    v_mov_b32 v119, 0
    v_mov_b32 v120, 0
    v_mov_b32 v121, 0
    v_mov_b32 v122, 0
    v_mov_b32 v123, 0
    v_mov_b32 v124, 0
    v_mov_b32 v125, 0
    v_mov_b32 v126, 0
    v_mov_b32 v127, 0
    s_mov_b32 s79, 114688
    s_add_u32 s80, s15, 147456
    s_mov_b32 s72, 0
    s_lshl_b32 s11, s2, 1
    s_add_u32 s11, s11, s86
    s_lshl_b32 s11, s11, 8
    s_add_u32 s11, s11, 0xf80000
    v_lshl_add_u32 v220, v21, 2, s11
    v_add_u32 v223, s79, v221
    v_add_u32 v224, s79, v222
    s_or_b32 s11, s81, 0
    v_xor_b32 v233, s11, v232
    v_xor_b32 v234, 32, v233
    s_waitcnt vmcnt(7)
    s_barrier
    s_add_u32 m0, s15, 131072
    s_nop 0
    buffer_load_dwordx4 v236, s[48:51], s75 offen lds
    s_add_u32 m0, s15, 135168
    s_nop 0
    buffer_load_dwordx4 v237, s[60:63], s75 offen lds
    s_add_u32 s75, s75, 114688
    s_cmp_eq_u32 s75, 1605632
    s_cselect_b32 s75, 0, s75
    s_add_u32 m0, s15, 139264
    s_nop 0
    buffer_load_dwordx4 v236, s[48:51], s75 offen lds
    s_add_u32 m0, s15, 143360
    s_nop 0
    buffer_load_dwordx4 v237, s[60:63], s75 offen lds
    s_add_u32 s75, s75, 114688
    s_cmp_eq_u32 s75, 1605632
    s_cselect_b32 s75, 0, s75
    s_waitcnt vmcnt(7)
    s_branch Lgu1
Lload_s:
    s_lshl_b32 s12, s83, 7
    s_add_u32 s12, s12, s14
    s_add_u32 s13, s83, 14336
    s_add_u32 m0, s12, 0
    s_nop 0
    buffer_load_dwordx4 v11, s[40:43], s83 offen lds
    s_add_u32 m0, s12, 1024
    s_nop 0
    buffer_load_dwordx4 v12, s[40:43], s83 offen lds
    s_add_u32 m0, s12, 2048
    s_nop 0
    buffer_load_dwordx4 v11, s[40:43], s13 offen lds
    s_add_u32 m0, s12, 3072
    s_nop 0
    buffer_load_dwordx4 v12, s[40:43], s13 offen lds
    s_add_u32 s83, s83, 128
    s_cmp_eq_u32 s83, 896
    s_cselect_b32 s83, 0, s83
    s_mul_i32 s11, s5, 224
    s_sub_u32 s11, s11, 896
    s_cmp_eq_u32 s5, 15
    s_cselect_b32 s11, 2432, s11
    v_lshrrev_b32 v27, 4, v251
    v_lshlrev_b32 v28, 2, v27
    v_xor_b32 v28, v28, v251
    v_and_b32 v28, 15, v28
    v_lshlrev_b32 v28, 4, v28
    s_lshr_b32 s38, s15, 7
    v_add_u32 v27, s38, v27
    v_mul_u32_u24 v27, 2688, v27
    v_add3_u32 v14, v27, v28, s11
    v_add_u32 v15, 10752, v14
    s_add_u32 m0, s15, 131072
    s_nop 0
    buffer_load_dwordx4 v13, s[44:47], s74 offen lds
    s_add_u32 m0, s76, 135168
    s_nop 0
    buffer_load_dwordx4 v14, s[44:47], s74 offen lds
    s_add_u32 m0, s76, 136192
    s_nop 0
    buffer_load_dwordx4 v15, s[44:47], s74 offen lds
    s_add_u32 s74, s74, 86016
    s_and_b32 s86, s3, 1
    s_bfe_u32 s87, s3, 0x10001
    s_lshl_b32 s11, s5, 1
    s_add_u32 s38, s5, 12
    s_cmp_eq_u32 s39, 1
    s_cselect_b32 s85, s38, s11
    v_mul_u32_u24 v27, 3584, v26
    s_lshl_b32 s11, s85, 7
    v_add3_u32 v236, v27, v25, s11
    v_xor_b32 v237, 32, v236
    s_mul_i32 s75, s82, 229376
    s_mov_b32 s52, s36
    s_mov_b32 s53, s37
    s_mov_b32 s54, 0x1000000
    s_mov_b32 s55, 0x20000
    s_mov_b32 s48, s24
    s_mov_b32 s49, s25
    s_mov_b32 s50, 0x188000
    s_mov_b32 s51, 0x20000
    s_mov_b32 s60, s26
    s_mov_b32 s61, s27
    s_mov_b32 s62, 0x188000
    s_mov_b32 s63, 0x20000
    s_mov_b32 s68, s34
    s_mov_b32 s69, s35
    s_mov_b32 s70, 0x100
    s_mov_b32 s71, 0x20000
    s_add_u32 m0, s15, 147456
    s_nop 0
    buffer_load_dwordx4 v13, s[44:47], s74 offen lds
    s_add_u32 m0, s76, 151552
    s_nop 0
    buffer_load_dwordx4 v14, s[44:47], s74 offen lds
    s_add_u32 m0, s76, 152576
    s_nop 0
    buffer_load_dwordx4 v15, s[44:47], s74 offen lds
    s_add_u32 s74, s74, 86016
    s_cmp_eq_u32 s74, 1204224
    s_cselect_b32 s74, 0, s74
    s_lshl_b32 s12, s83, 7
    s_add_u32 s12, s12, s14
    s_add_u32 s13, s83, 14336
    s_add_u32 m0, s12, 0
    s_nop 0
    buffer_load_dwordx4 v11, s[40:43], s83 offen lds
    s_add_u32 m0, s12, 1024
    s_nop 0
    buffer_load_dwordx4 v12, s[40:43], s83 offen lds
    s_add_u32 m0, s12, 2048
    s_nop 0
    buffer_load_dwordx4 v11, s[40:43], s13 offen lds
    s_add_u32 m0, s12, 3072
    s_nop 0
    buffer_load_dwordx4 v12, s[40:43], s13 offen lds
    s_add_u32 s83, s83, 128
    s_cmp_eq_u32 s83, 896
    s_cselect_b32 s83, 0, s83
    s_add_u32 m0, s15, 114688
    s_nop 0
    buffer_load_dwordx4 v13, s[44:47], s74 offen lds
    s_add_u32 m0, s76, 118784
    s_nop 0
    buffer_load_dwordx4 v14, s[44:47], s74 offen lds
    s_add_u32 m0, s76, 119808
    s_nop 0
    buffer_load_dwordx4 v15, s[44:47], s74 offen lds
    s_add_u32 s74, s74, 86016
    s_waitcnt vmcnt(10)
    s_barrier
    s_lshl_b32 s12, s83, 7
    s_add_u32 s12, s12, s14
    s_add_u32 s13, s83, 14336
    s_add_u32 m0, s12, 0
    s_nop 0
    buffer_load_dwordx4 v11, s[40:43], s83 offen lds
    s_add_u32 m0, s12, 1024
    s_nop 0
    buffer_load_dwordx4 v12, s[40:43], s83 offen lds
    s_add_u32 m0, s12, 2048
    s_nop 0
    buffer_load_dwordx4 v11, s[40:43], s13 offen lds
    s_waitcnt vmcnt(10)
    s_barrier
    s_add_u32 m0, s15, 131072
    s_nop 0
    buffer_load_dwordx4 v13, s[44:47], s74 offen lds
    s_add_u32 m0, s76, 135168
    s_nop 0
    buffer_load_dwordx4 v14, s[44:47], s74 offen lds
    s_add_u32 m0, s76, 136192
    s_nop 0
    buffer_load_dwordx4 v15, s[44:47], s74 offen lds
    s_add_u32 s74, s74, 86016
    s_cmp_eq_u32 s74, 1204224
    s_cselect_b32 s74, 0, s74
    s_add_u32 m0, s12, 3072
    s_nop 0
    buffer_load_dwordx4 v12, s[40:43], s13 offen lds
    s_add_u32 s83, s83, 128
    s_cmp_eq_u32 s83, 896
    s_cselect_b32 s83, 0, s83
    s_lshl_b32 s12, s83, 7
    s_add_u32 s12, s12, s14
    s_add_u32 s13, s83, 14336
    s_add_u32 m0, s12, 0
    s_nop 0
    buffer_load_dwordx4 v11, s[40:43], s83 offen lds
    s_add_u32 m0, s12, 1024
    s_nop 0
    buffer_load_dwordx4 v12, s[40:43], s83 offen lds
    s_waitcnt vmcnt(9)
    s_barrier
    s_add_u32 m0, s15, 147456
    s_nop 0
    buffer_load_dwordx4 v13, s[44:47], s74 offen lds
    s_add_u32 m0, s76, 151552
    s_nop 0
    buffer_load_dwordx4 v14, s[44:47], s74 offen lds
    s_add_u32 m0, s76, 152576
    s_nop 0
    buffer_load_dwordx4 v15, s[44:47], s74 offen lds
    s_add_u32 s74, s74, 86016
    s_add_u32 m0, s12, 2048
    s_nop 0
    buffer_load_dwordx4 v11, s[40:43], s13 offen lds
    s_add_u32 m0, s12, 3072
    s_nop 0
    buffer_load_dwordx4 v12, s[40:43], s13 offen lds
    s_add_u32 s83, s83, 128
    s_cmp_eq_u32 s83, 896
    s_cselect_b32 s83, 0, s83
    s_lshl_b32 s12, s83, 7
    s_add_u32 s12, s12, s14
    s_add_u32 s13, s83, 14336
    s_add_u32 m0, s12, 0
    s_nop 0
    buffer_load_dwordx4 v11, s[40:43], s83 offen lds
    s_waitcnt vmcnt(9)
    s_barrier
    s_add_u32 m0, s15, 114688
    s_nop 0
    buffer_load_dwordx4 v13, s[44:47], s74 offen lds
    s_add_u32 m0, s76, 118784
    s_nop 0
    buffer_load_dwordx4 v14, s[44:47], s74 offen lds
    s_add_u32 m0, s76, 119808
    s_nop 0
    buffer_load_dwordx4 v15, s[44:47], s74 offen lds
    s_add_u32 s74, s74, 86016
    s_cmp_eq_u32 s74, 1204224
    s_cselect_b32 s74, 0, s74
    s_add_u32 m0, s12, 1024
    s_nop 0
    buffer_load_dwordx4 v12, s[40:43], s83 offen lds
    s_add_u32 m0, s12, 2048
    s_nop 0
    buffer_load_dwordx4 v11, s[40:43], s13 offen lds
    s_add_u32 m0, s12, 3072
    s_nop 0
    buffer_load_dwordx4 v12, s[40:43], s13 offen lds
    s_add_u32 s83, s83, 128
    s_cmp_eq_u32 s83, 896
    s_cselect_b32 s83, 0, s83
    s_waitcnt vmcnt(9)
    s_barrier
    s_add_u32 m0, s15, 131072
    s_nop 0
    buffer_load_dwordx4 v13, s[44:47], s74 offen lds
    s_add_u32 m0, s76, 135168
    s_nop 0
    buffer_load_dwordx4 v14, s[44:47], s74 offen lds
    s_add_u32 m0, s76, 136192
    s_nop 0
    buffer_load_dwordx4 v15, s[44:47], s74 offen lds
    s_add_u32 s74, s74, 86016
    s_lshl_b32 s12, s83, 7
    s_add_u32 s12, s12, s14
    s_add_u32 s13, s83, 14336
    s_add_u32 m0, s12, 0
    s_nop 0
    buffer_load_dwordx4 v11, s[40:43], s83 offen lds
    s_add_u32 m0, s12, 1024
    s_nop 0
    buffer_load_dwordx4 v12, s[40:43], s83 offen lds
    s_add_u32 m0, s12, 2048
    s_nop 0
    buffer_load_dwordx4 v11, s[40:43], s13 offen lds
    s_waitcnt vmcnt(9)
    s_barrier
    s_add_u32 m0, s15, 147456
    s_nop 0
    buffer_load_dwordx4 v13, s[44:47], s74 offen lds
    s_add_u32 m0, s76, 151552
    s_nop 0
    buffer_load_dwordx4 v14, s[44:47], s74 offen lds
    s_add_u32 m0, s76, 152576
    s_nop 0
    buffer_load_dwordx4 v15, s[44:47], s74 offen lds
    s_add_u32 s74, s74, 86016
    s_cmp_eq_u32 s74, 1204224
    s_cselect_b32 s74, 0, s74
    s_add_u32 m0, s12, 3072
    s_nop 0
    buffer_load_dwordx4 v12, s[40:43], s13 offen lds
    s_add_u32 s83, s83, 128
    s_cmp_eq_u32 s83, 896
    s_cselect_b32 s83, 0, s83
    s_lshl_b32 s12, s83, 7
    s_add_u32 s12, s12, s14
    s_add_u32 s13, s83, 14336
    s_add_u32 m0, s12, 0
    s_nop 0
    buffer_load_dwordx4 v11, s[40:43], s83 offen lds
    s_add_u32 m0, s12, 1024
    s_nop 0
    buffer_load_dwordx4 v12, s[40:43], s83 offen lds
    s_waitcnt vmcnt(9)
    s_barrier
    s_add_u32 m0, s15, 114688
    s_nop 0
    buffer_load_dwordx4 v13, s[44:47], s74 offen lds
    s_add_u32 m0, s76, 118784
    s_nop 0
    buffer_load_dwordx4 v14, s[44:47], s74 offen lds
    s_add_u32 m0, s76, 119808
    s_nop 0
    buffer_load_dwordx4 v15, s[44:47], s74 offen lds
    s_add_u32 s74, s74, 86016
    s_add_u32 m0, s12, 2048
    s_nop 0
    buffer_load_dwordx4 v11, s[40:43], s13 offen lds
    s_add_u32 m0, s12, 3072
    s_nop 0
    buffer_load_dwordx4 v12, s[40:43], s13 offen lds
    s_add_u32 s83, s83, 128
    s_cmp_eq_u32 s83, 896
    s_cselect_b32 s83, 0, s83
    s_and_b32 s11, s2, 7
    s_lshr_b32 s12, s2, 3
    s_lshl_b32 s13, s11, 1
    s_lshr_b32 s38, s12, 4
    s_add_u32 s6, s13, s38
    s_and_b32 s7, s12, 15
    s_mov_b32 s98, 0xffff0000
    s_mov_b32 s99, 0xffff0000
    v_bfe_u32 v18, v251, 2, 2
    v_and_b32 v19, 3, v251
    v_lshlrev_b32 v19, 3, v19
    v_lshrrev_b32 v20, 5, v251
    v_and_b32 v21, 31, v251
    v_lshl_add_u32 v22, v20, 3, v18
    v_lshlrev_b32 v22, 7, v22
    v_lshrrev_b32 v23, 1, v18
    v_lshlrev_b32 v23, 6, v23
    v_bfe_u32 v24, v21, 1, 3
    v_xor_b32 v24, v24, v20
    v_lshlrev_b32 v24, 4, v24
    s_lshl_b32 s11, s86, 13
    v_lshl_add_u32 v232, v21, 7, v24
    s_waitcnt vmcnt(8)
    s_barrier
    s_add_u32 m0, s15, 131072
    s_nop 0
    buffer_load_dwordx4 v13, s[44:47], s74 offen lds
    s_add_u32 m0, s76, 135168
    s_nop 0
    buffer_load_dwordx4 v14, s[44:47], s74 offen lds
    s_add_u32 m0, s76, 136192
    s_nop 0
    buffer_load_dwordx4 v15, s[44:47], s74 offen lds
    s_add_u32 s74, s74, 86016
    s_cmp_eq_u32 s74, 1204224
    s_cselect_b32 s74, 0, s74
    v_add_u32 v232, s11, v232
    s_lshl_b32 s81, s82, 14
    s_lshl_b32 s11, s87, 6
    s_add_u32 s11, s11, 0
    s_xor_b32 s12, s11, 4128
    v_mov_b32 v27, s11
    v_mov_b32 v28, s12
    v_cndmask_b32 v27, v27, v28, s[98:99]
    v_add_u32 v27, v27, v19
    v_xor_b32 v27, v27, v23
    v_add_u32 v221, v27, v22
    s_lshl_b32 s11, s87, 6
    s_add_u32 s11, s11, 32
    s_xor_b32 s12, s11, 4128
    v_mov_b32 v27, s11
    v_mov_b32 v28, s12
    v_cndmask_b32 v27, v27, v28, s[98:99]
    v_add_u32 v27, v27, v19
    v_xor_b32 v27, v27, v23
    v_add_u32 v222, v27, v22
    s_mov_b32 s94, 0xbdd2d3e8
    s_mov_b32 s95, 0xc0135761
    s_waitcnt vmcnt(5)
    s_barrier
    s_add_u32 m0, s15, 147456
    s_nop 0
    buffer_load_dwordx4 v13, s[44:47], s74 offen lds
    s_add_u32 m0, s76, 151552
    s_nop 0
    buffer_load_dwordx4 v14, s[44:47], s74 offen lds
    s_add_u32 m0, s76, 152576
    s_nop 0
    buffer_load_dwordx4 v15, s[44:47], s74 offen lds
    s_add_u32 s74, s74, 86016
    v_mov_b32 v235, s95
    v_mov_b32 v32, 0
    v_mov_b32 v33, 0
    v_mov_b32 v34, 0
    v_mov_b32 v35, 0
    v_mov_b32 v36, 0
    v_mov_b32 v37, 0
    v_mov_b32 v38, 0
    v_mov_b32 v39, 0
    v_mov_b32 v40, 0
    v_mov_b32 v41, 0
    v_mov_b32 v42, 0
    v_mov_b32 v43, 0
    v_mov_b32 v44, 0
    v_mov_b32 v45, 0
    v_mov_b32 v46, 0
    v_mov_b32 v47, 0
    v_mov_b32 v48, 0
    v_mov_b32 v49, 0
    v_mov_b32 v50, 0
    v_mov_b32 v51, 0
    v_mov_b32 v52, 0
    s_waitcnt vmcnt(3)
    s_barrier
    s_add_u32 m0, s15, 114688
    s_nop 0
    buffer_load_dwordx4 v13, s[44:47], s74 offen lds
    s_add_u32 m0, s76, 118784
    s_nop 0
    buffer_load_dwordx4 v14, s[44:47], s74 offen lds
    s_add_u32 m0, s76, 119808
    s_nop 0
    buffer_load_dwordx4 v15, s[44:47], s74 offen lds
    s_add_u32 s74, s74, 86016
    s_cmp_eq_u32 s74, 1204224
    s_cselect_b32 s74, 0, s74
    v_mov_b32 v53, 0
    v_mov_b32 v54, 0
    v_mov_b32 v55, 0
    v_mov_b32 v56, 0
    v_mov_b32 v57, 0
    v_mov_b32 v58, 0
    v_mov_b32 v59, 0
    v_mov_b32 v60, 0
    v_mov_b32 v61, 0
    v_mov_b32 v62, 0
    v_mov_b32 v63, 0
    v_mov_b32 v64, 0
    v_mov_b32 v65, 0
    v_mov_b32 v66, 0
    v_mov_b32 v67, 0
    v_mov_b32 v68, 0
    v_mov_b32 v69, 0
    v_mov_b32 v70, 0
    v_mov_b32 v71, 0
    v_mov_b32 v72, 0
    v_mov_b32 v73, 0
    v_mov_b32 v74, 0
    s_waitcnt vmcnt(3)
    s_barrier
    s_add_u32 m0, s15, 131072
    s_nop 0
    buffer_load_dwordx4 v13, s[44:47], s74 offen lds
    s_add_u32 m0, s76, 135168
    s_nop 0
    buffer_load_dwordx4 v14, s[44:47], s74 offen lds
    s_add_u32 m0, s76, 136192
    s_nop 0
    buffer_load_dwordx4 v15, s[44:47], s74 offen lds
    s_add_u32 s74, s74, 86016
    v_mov_b32 v75, 0
    v_mov_b32 v76, 0
    v_mov_b32 v77, 0
    v_mov_b32 v78, 0
    v_mov_b32 v79, 0
    v_mov_b32 v80, 0
    v_mov_b32 v81, 0
    v_mov_b32 v82, 0
    v_mov_b32 v83, 0
    v_mov_b32 v84, 0
    v_mov_b32 v85, 0
    v_mov_b32 v86, 0
    v_mov_b32 v87, 0
    v_mov_b32 v88, 0
    v_mov_b32 v89, 0
    v_mov_b32 v90, 0
    v_mov_b32 v91, 0
    v_mov_b32 v92, 0
    v_mov_b32 v93, 0
    v_mov_b32 v94, 0
    v_mov_b32 v95, 0
    v_mov_b32 v96, 0
    s_waitcnt vmcnt(3)
    s_barrier
    s_add_u32 m0, s15, 147456
    s_nop 0
    buffer_load_dwordx4 v13, s[44:47], s74 offen lds
    s_add_u32 m0, s76, 151552
    s_nop 0
    buffer_load_dwordx4 v14, s[44:47], s74 offen lds
    s_add_u32 m0, s76, 152576
    s_nop 0
    buffer_load_dwordx4 v15, s[44:47], s74 offen lds
    s_add_u32 s74, s74, 86016
    s_cmp_eq_u32 s74, 1204224
    s_cselect_b32 s74, 0, s74
    v_mov_b32 v97, 0
    v_mov_b32 v98, 0
    v_mov_b32 v99, 0
    v_mov_b32 v100, 0
    v_mov_b32 v101, 0
    v_mov_b32 v102, 0
    v_mov_b32 v103, 0
    v_mov_b32 v104, 0
    v_mov_b32 v105, 0
    v_mov_b32 v106, 0
    v_mov_b32 v107, 0
    v_mov_b32 v108, 0
    v_mov_b32 v109, 0
    v_mov_b32 v110, 0
    v_mov_b32 v111, 0
    v_mov_b32 v112, 0
    v_mov_b32 v113, 0
    v_mov_b32 v114, 0
    v_mov_b32 v115, 0
    v_mov_b32 v116, 0
    v_mov_b32 v117, 0
    v_mov_b32 v118, 0
    s_waitcnt vmcnt(3)
    s_barrier
    s_add_u32 m0, s15, 114688
    s_nop 0
    buffer_load_dwordx4 v236, s[48:51], s75 offen lds
    s_add_u32 m0, s15, 118784
    s_nop 0
    buffer_load_dwordx4 v237, s[60:63], s75 offen lds
    s_add_u32 s75, s75, 114688
    s_cmp_eq_u32 s75, 1605632
    s_cselect_b32 s75, 0, s75
    s_add_u32 m0, s15, 122880
    s_nop 0
    buffer_load_dwordx4 v236, s[48:51], s75 offen lds
    s_add_u32 m0, s15, 126976
    s_nop 0
    buffer_load_dwordx4 v237, s[60:63], s75 offen lds
    s_add_u32 s75, s75, 114688
    s_cmp_eq_u32 s75, 1605632
    s_cselect_b32 s75, 0, s75
    v_mov_b32 v119, 0
    v_mov_b32 v120, 0
    v_mov_b32 v121, 0
    v_mov_b32 v122, 0
    v_mov_b32 v123, 0
    v_mov_b32 v124, 0
    v_mov_b32 v125, 0
    v_mov_b32 v126, 0
    v_mov_b32 v127, 0
    s_mov_b32 s79, 114688
    s_add_u32 s80, s15, 147456
    s_mov_b32 s72, 0
    s_lshl_b32 s11, s2, 1
    s_add_u32 s11, s11, s86
    s_lshl_b32 s11, s11, 8
    s_add_u32 s11, s11, 0xf80000
    v_lshl_add_u32 v220, v21, 2, s11
    v_add_u32 v223, s79, v221
    v_add_u32 v224, s79, v222
    s_or_b32 s11, s81, 0
    v_xor_b32 v233, s11, v232
    v_xor_b32 v234, 32, v233
    s_waitcnt vmcnt(4)
    s_barrier
    s_add_u32 m0, s15, 131072
    s_nop 0
    buffer_load_dwordx4 v236, s[48:51], s75 offen lds
    s_add_u32 m0, s15, 135168
    s_nop 0
    buffer_load_dwordx4 v237, s[60:63], s75 offen lds
    s_add_u32 s75, s75, 114688
    s_cmp_eq_u32 s75, 1605632
    s_cselect_b32 s75, 0, s75
    s_add_u32 m0, s15, 139264
    s_nop 0
    buffer_load_dwordx4 v236, s[48:51], s75 offen lds
    s_add_u32 m0, s15, 143360
    s_nop 0
    buffer_load_dwordx4 v237, s[60:63], s75 offen lds
    s_add_u32 s75, s75, 114688
    s_cmp_eq_u32 s75, 1605632
    s_cselect_b32 s75, 0, s75
    s_waitcnt vmcnt(4)
Lgu1:
    s_setprio 3
    s_barrier
    ds_read_b128 v[0:3], v233 offset:0
    ds_read_b128 v[4:7], v233 offset:4096
    ds_read_b64_tr_b16 v[8:9], v223 offset:0
    ds_read_b64_tr_b16 v[10:11], v223 offset:512
    ds_read_b64_tr_b16 v[12:13], v224 offset:0
    ds_read_b64_tr_b16 v[14:15], v224 offset:512
    ds_read_b128 v[16:19], v234 offset:0
    ds_read_b128 v[20:23], v234 offset:4096
    ds_read_b64_tr_b16 v[24:25], v223 offset:2048
    ds_read_b64_tr_b16 v[26:27], v223 offset:2560
    ds_read_b64_tr_b16 v[28:29], v224 offset:2048
    ds_read_b64_tr_b16 v[30:31], v224 offset:2560
    s_add_u32 m0, s80, 0
    s_nop 0
    buffer_load_dwordx4 v236, s[48:51], s75 offen lds
    v_add_u32 v244, 0x2000, v223
    v_add_u32 v245, 0x2000, v224
    s_add_u32 m0, s80, 4096
    s_nop 0
    buffer_load_dwordx4 v237, s[60:63], s75 offen lds
    s_add_u32 s75, s75, 114688
    s_cmp_eq_u32 s75, 1605632
    s_cselect_b32 s75, 0, s75
    v_xor_b32 v246, 64, v233
    s_add_u32 m0, s80, 8192
    s_nop 0
    buffer_load_dwordx4 v236, s[48:51], s75 offen lds
    v_xor_b32 v247, 64, v234
    s_add_u32 m0, s80, 12288
    s_nop 0
    buffer_load_dwordx4 v237, s[60:63], s75 offen lds
    s_add_u32 s75, s75, 114688
    s_cmp_eq_u32 s75, 1605632
    s_cselect_b32 s75, 0, s75
    s_add_u32 s80, s79, s15
    s_add_u32 s79, s79, 16384
    s_branch Lgu1_mid
.p2align 5
Lgu1_loop:
    v_mfma_f32_32x32x16_bf16 v[64:79], v[40:43], v[32:35], v[64:79]
    ds_read_b128 v[0:3], v233 offset:0
    ds_read_b128 v[4:7], v233 offset:4096
    s_cmp_lg_u32 s72, 5
    s_cbranch_scc1 Lgu1_b
    v_add_u32 v236, 128, v236
    v_add_u32 v237, 128, v237
    s_cmp_eq_u32 s39, 1
    s_cselect_b32 s75, 0x40000000, s75
Lgu1_b:
    v_mfma_f32_32x32x16_bf16 v[80:95], v[40:43], v[36:39], v[80:95]
    ds_read_b64_tr_b16 v[8:9], v223 offset:0
    ds_read_b64_tr_b16 v[10:11], v223 offset:512
    s_add_u32 m0, s80, 0
    s_nop 0
    buffer_load_dwordx4 v236, s[48:51], s75 offen lds
    v_mfma_f32_32x32x16_bf16 v[96:111], v[44:47], v[32:35], v[96:111]
    ds_read_b64_tr_b16 v[12:13], v224 offset:0
    ds_read_b64_tr_b16 v[14:15], v224 offset:512
    v_add_u32 v244, 0x2000, v223
    v_add_u32 v245, 0x2000, v224
    v_mfma_f32_32x32x16_bf16 v[112:127], v[44:47], v[36:39], v[112:127]
    ds_read_b128 v[16:19], v234 offset:0
    ds_read_b128 v[20:23], v234 offset:4096
    s_add_u32 m0, s80, 4096
    s_nop 0
    buffer_load_dwordx4 v237, s[60:63], s75 offen lds
    v_mfma_f32_32x32x16_bf16 v[64:79], v[56:59], v[48:51], v[64:79]
    ds_read_b64_tr_b16 v[24:25], v223 offset:2048
    ds_read_b64_tr_b16 v[26:27], v223 offset:2560
    s_add_u32 s75, s75, 114688
    s_cmp_eq_u32 s75, 1605632
    s_cselect_b32 s75, 0, s75
    v_xor_b32 v246, 64, v233
    v_mfma_f32_32x32x16_bf16 v[80:95], v[56:59], v[52:55], v[80:95]
    ds_read_b64_tr_b16 v[28:29], v224 offset:2048
    ds_read_b64_tr_b16 v[30:31], v224 offset:2560
    s_add_u32 m0, s80, 8192
    s_nop 0
    buffer_load_dwordx4 v236, s[48:51], s75 offen lds
    v_xor_b32 v247, 64, v234
    v_mfma_f32_32x32x16_bf16 v[96:111], v[60:63], v[48:51], v[96:111]
    s_add_u32 m0, s80, 12288
    s_nop 0
    buffer_load_dwordx4 v237, s[60:63], s75 offen lds
    v_mfma_f32_32x32x16_bf16 v[112:127], v[60:63], v[52:55], v[112:127]
    s_add_u32 s75, s75, 114688
    s_cmp_eq_u32 s75, 1605632
    s_cselect_b32 s75, 0, s75
    s_add_u32 s80, s79, s15
    s_add_u32 s79, s79, 16384
Lgu1_mid:
    s_waitcnt lgkmcnt(8)
    v_mfma_f32_32x32x16_bf16 v[64:79], v[8:11], v[0:3], v[64:79]
    ds_read_b128 v[32:35], v246 offset:0
    ds_read_b128 v[36:39], v246 offset:4096
    ds_read_b64_tr_b16 v[40:41], v244 offset:0
    v_mfma_f32_32x32x16_bf16 v[80:95], v[8:11], v[4:7], v[80:95]
    ds_read_b64_tr_b16 v[42:43], v244 offset:512
    ds_read_b64_tr_b16 v[44:45], v245 offset:0
    ds_read_b64_tr_b16 v[46:47], v245 offset:512
    s_waitcnt lgkmcnt(12)
    v_mfma_f32_32x32x16_bf16 v[96:111], v[12:15], v[0:3], v[96:111]
    ds_read_b128 v[48:51], v247 offset:0
    ds_read_b128 v[52:55], v247 offset:4096
    ds_read_b64_tr_b16 v[56:57], v244 offset:2048
    v_mfma_f32_32x32x16_bf16 v[112:127], v[12:15], v[4:7], v[112:127]
    ds_read_b64_tr_b16 v[58:59], v244 offset:2560
    ds_read_b64_tr_b16 v[60:61], v245 offset:2048
    ds_read_b64_tr_b16 v[62:63], v245 offset:2560
    s_cmp_eq_u32 s79, 163840
    s_cselect_b32 s79, 114688, s79
    s_waitcnt lgkmcnt(12)
    v_mfma_f32_32x32x16_bf16 v[64:79], v[24:27], v[16:19], v[64:79]
    s_add_u32 s81, s81, 16384
    s_cmp_eq_u32 s81, 114688
    s_cselect_b32 s81, 0, s81
    v_add_u32 v223, s79, v221
    v_add_u32 v224, s79, v222
    v_xor_b32 v233, s81, v232
    v_xor_b32 v234, 32, v233
    v_mfma_f32_32x32x16_bf16 v[80:95], v[24:27], v[20:23], v[80:95]
    s_waitcnt vmcnt(4) lgkmcnt(0)
    s_barrier
    v_mfma_f32_32x32x16_bf16 v[96:111], v[28:31], v[16:19], v[96:111]
    s_cmp_lg_u32 s72, 5
    s_cbranch_scc1 Lgu1_c
    buffer_load_dword v216, v220, s[52:55], 0 offen sc1
    buffer_load_dword v218, v220, s[52:55], 0 offen offset:128 sc1
    buffer_load_dword v240, v252, s[68:71], 0 offen sc1
Lgu1_c:
    s_add_u32 s72, s72, 1
    s_cmp_lt_u32 s72, 7
    v_mfma_f32_32x32x16_bf16 v[112:127], v[28:31], v[20:23], v[112:127]
    s_cbranch_scc1 Lgu1_loop
    s_cmp_eq_u32 s39, 1
    s_cbranch_scc1 Lgu_end_s
    v_mfma_f32_32x32x16_bf16 v[64:79], v[40:43], v[32:35], v[64:79]
    ds_read_b128 v[0:3], v233 offset:0
    ds_read_b128 v[4:7], v233 offset:4096
    s_lshl_b32 s76, s4, 1
    s_add_u32 s76, s76, s86
    s_lshl_b32 s76, s76, 1
    s_mul_i32 s76, s76, 114688
    s_lshl_b32 s11, s85, 1
    v_mfma_f32_32x32x16_bf16 v[80:95], v[40:43], v[36:39], v[80:95]
    ds_read_b64_tr_b16 v[8:9], v223 offset:0
    ds_read_b64_tr_b16 v[10:11], v223 offset:512
    s_add_u32 s11, s11, s87
    s_lshl_b32 s12, s11, 11
    s_add_u32 s76, s76, s12
    s_add_u32 s76, s76, 0x600000
    s_add_u32 s78, s76, 114688
    v_mfma_f32_32x32x16_bf16 v[96:111], v[44:47], v[32:35], v[96:111]
    ds_read_b64_tr_b16 v[12:13], v224 offset:0
    ds_read_b64_tr_b16 v[14:15], v224 offset:512
    v_add_u32 v244, 0x2000, v223
    v_add_u32 v245, 0x2000, v224
    v_mfma_f32_32x32x16_bf16 v[112:127], v[44:47], v[36:39], v[112:127]
    ds_read_b128 v[16:19], v234 offset:0
    ds_read_b128 v[20:23], v234 offset:4096
    v_xor_b32 v246, 64, v233
    v_xor_b32 v247, 64, v234
    v_mfma_f32_32x32x16_bf16 v[64:79], v[56:59], v[48:51], v[64:79]
    ds_read_b64_tr_b16 v[24:25], v223 offset:2048
    ds_read_b64_tr_b16 v[26:27], v223 offset:2560
    s_lshl_b32 s12, s4, 1
    s_add_u32 s12, s12, s86
    s_mul_i32 s12, s12, 56
    s_add_u32 s11, s11, s12
    s_lshl_b32 s11, s11, 7
    v_mfma_f32_32x32x16_bf16 v[80:95], v[56:59], v[52:55], v[80:95]
    ds_read_b64_tr_b16 v[28:29], v224 offset:2048
    ds_read_b64_tr_b16 v[30:31], v224 offset:2560
    s_add_u32 s11, s11, 0xf40000
    v_mov_b32 v249, s11
    v_mfma_f32_32x32x16_bf16 v[96:111], v[60:63], v[48:51], v[96:111]
    s_mov_b32 s89, 1048576
Lg2_n1:
    v_readfirstlane_b32 s10, v240
    s_nop 1
    s_cmp_lg_u32 s10, 0
    s_cbranch_scc1 Lg2_n2
    s_sub_u32 s89, s89, 1
    s_cbranch_scc1 Lg2_n2
    buffer_load_dword v240, v252, s[68:71], 0 offen sc1
    s_waitcnt vmcnt(0)
    s_branch Lg2_n1
Lg2_n2:
    v_mov_b32 v242, s10
    v_mfma_f32_32x32x16_bf16 v[112:127], v[60:63], v[52:55], v[112:127]
    s_waitcnt lgkmcnt(8)
    v_mfma_f32_32x32x16_bf16 v[128:143], v[8:11], v[0:3], 0
    ds_read_b128 v[32:35], v246 offset:0
    ds_read_b128 v[36:39], v246 offset:4096
    ds_read_b64_tr_b16 v[40:41], v244 offset:0
    v_mul_f32 v192, v64, v64
    v_mul_f32 v193, v65, v65
    v_mul_f32 v194, v66, v66
    v_mul_f32 v195, v67, v67
    v_mfma_f32_32x32x16_bf16 v[144:159], v[8:11], v[4:7], 0
    ds_read_b64_tr_b16 v[42:43], v244 offset:512
    ds_read_b64_tr_b16 v[44:45], v245 offset:0
    ds_read_b64_tr_b16 v[46:47], v245 offset:512
    v_mul_f32 v196, v68, v68
    v_mul_f32 v197, v69, v69
    v_mul_f32 v198, v70, v70
    s_waitcnt lgkmcnt(12)
    v_mfma_f32_32x32x16_bf16 v[160:175], v[12:15], v[0:3], 0
    ds_read_b128 v[48:51], v247 offset:0
    ds_read_b128 v[52:55], v247 offset:4096
    ds_read_b64_tr_b16 v[56:57], v244 offset:2048
    v_mul_f32 v199, v71, v71
    v_fma_f32 v192, v192, s94, v235
    v_fma_f32 v193, v193, s94, v235
    v_fma_f32 v194, v194, s94, v235
    v_mfma_f32_32x32x16_bf16 v[176:191], v[12:15], v[4:7], 0
    ds_read_b64_tr_b16 v[58:59], v244 offset:2560
    ds_read_b64_tr_b16 v[60:61], v245 offset:2048
    ds_read_b64_tr_b16 v[62:63], v245 offset:2560
    v_fma_f32 v195, v195, s94, v235
    v_fma_f32 v196, v196, s94, v235
    v_fma_f32 v197, v197, s94, v235
    s_waitcnt lgkmcnt(12)
    v_mfma_f32_32x32x16_bf16 v[128:143], v[24:27], v[16:19], v[128:143]
    s_add_u32 s81, s81, 16384
    s_cmp_eq_u32 s81, 114688
    s_cselect_b32 s81, 0, s81
    v_add_u32 v223, 0x24000, v221
    v_add_u32 v224, 0x24000, v222
    v_xor_b32 v233, s81, v232
    v_xor_b32 v234, 32, v233
    v_mfma_f32_32x32x16_bf16 v[144:159], v[24:27], v[20:23], v[144:159]
    s_waitcnt vmcnt(0) lgkmcnt(0)
    s_barrier
    v_mfma_f32_32x32x16_bf16 v[160:175], v[28:31], v[16:19], v[160:175]
    v_fma_f32 v198, v198, s94, v235
    v_fma_f32 v199, v199, s94, v235
    v_mul_f32 v192, v192, v64
    v_mul_f32 v193, v193, v65
    v_mul_f32 v194, v194, v66
    v_mul_f32 v195, v195, v67
    v_mul_f32 v196, v196, v68
    v_mfma_f32_32x32x16_bf16 v[176:191], v[28:31], v[20:23], v[176:191]
    v_mul_f32 v197, v197, v69
    v_mul_f32 v198, v198, v70
    v_mul_f32 v199, v199, v71
    v_exp_f32 v192, v192
    v_mul_f32 v72, v72, v64
    v_mfma_f32_32x32x16_bf16 v[128:143], v[40:43], v[32:35], v[128:143]
    ds_read_b128 v[0:3], v233 offset:0
    ds_read_b128 v[4:7], v233 offset:4096
    v_exp_f32 v193, v193
    v_mul_f32 v73, v73, v65
    v_exp_f32 v194, v194
    v_mfma_f32_32x32x16_bf16 v[144:159], v[40:43], v[36:39], v[144:159]
    ds_read_b64_tr_b16 v[8:9], v223 offset:0
    ds_read_b64_tr_b16 v[10:11], v223 offset:512
    v_mul_f32 v74, v74, v66
    v_exp_f32 v195, v195
    v_mul_f32 v75, v75, v67
    v_mfma_f32_32x32x16_bf16 v[160:175], v[44:47], v[32:35], v[160:175]
    ds_read_b64_tr_b16 v[12:13], v224 offset:0
    ds_read_b64_tr_b16 v[14:15], v224 offset:512
    v_add_u32 v244, 0x2000, v223
    v_add_u32 v245, 0x2000, v224
    v_exp_f32 v196, v196
    v_mul_f32 v76, v76, v68
    v_mfma_f32_32x32x16_bf16 v[176:191], v[44:47], v[36:39], v[176:191]
    ds_read_b128 v[16:19], v234 offset:0
    ds_read_b128 v[20:23], v234 offset:4096
    v_xor_b32 v246, 64, v233
    v_xor_b32 v247, 64, v234
    v_exp_f32 v197, v197
    v_mul_f32 v77, v77, v69
    v_mfma_f32_32x32x16_bf16 v[128:143], v[56:59], v[48:51], v[128:143]
    ds_read_b64_tr_b16 v[24:25], v223 offset:2048
    ds_read_b64_tr_b16 v[26:27], v223 offset:2560
    v_exp_f32 v198, v198
    v_mul_f32 v78, v78, v70
    v_exp_f32 v199, v199
    v_mfma_f32_32x32x16_bf16 v[144:159], v[56:59], v[52:55], v[144:159]
    ds_read_b64_tr_b16 v[28:29], v224 offset:2048
    ds_read_b64_tr_b16 v[30:31], v224 offset:2560
    v_mul_f32 v79, v79, v71
    v_fma_f32 v192, v192, v216, v216
    v_fma_f32 v193, v193, v216, v216
    v_fma_f32 v194, v194, v216, v216
    v_fma_f32 v195, v195, v216, v216
    v_mfma_f32_32x32x16_bf16 v[160:175], v[60:63], v[48:51], v[160:175]
    v_fma_f32 v196, v196, v216, v216
    v_fma_f32 v197, v197, v216, v216
    v_fma_f32 v198, v198, v216, v216
    v_fma_f32 v199, v199, v216, v216
    v_rcp_f32 v192, v192
    v_mfma_f32_32x32x16_bf16 v[176:191], v[60:63], v[52:55], v[176:191]
    v_rcp_f32 v193, v193
    v_rcp_f32 v194, v194
    v_mul_f32 v72, v72, v192
    v_rcp_f32 v195, v195
    s_waitcnt lgkmcnt(8)
    v_mfma_f32_32x32x16_bf16 v[128:143], v[8:11], v[0:3], v[128:143]
    ds_read_b128 v[32:35], v246 offset:0
    ds_read_b128 v[36:39], v246 offset:4096
    ds_read_b64_tr_b16 v[40:41], v244 offset:0
    v_mul_f32 v73, v73, v193
    v_rcp_f32 v196, v196
    v_mul_f32 v74, v74, v194
    v_mfma_f32_32x32x16_bf16 v[144:159], v[8:11], v[4:7], v[144:159]
    ds_read_b64_tr_b16 v[42:43], v244 offset:512
    ds_read_b64_tr_b16 v[44:45], v245 offset:0
    ds_read_b64_tr_b16 v[46:47], v245 offset:512
    v_rcp_f32 v197, v197
    v_mul_f32 v75, v75, v195
    s_waitcnt lgkmcnt(12)
    v_mfma_f32_32x32x16_bf16 v[160:175], v[12:15], v[0:3], v[160:175]
    ds_read_b128 v[48:51], v247 offset:0
    ds_read_b128 v[52:55], v247 offset:4096
    ds_read_b64_tr_b16 v[56:57], v244 offset:2048
    v_rcp_f32 v198, v198
    v_mul_f32 v76, v76, v196
    v_mfma_f32_32x32x16_bf16 v[176:191], v[12:15], v[4:7], v[176:191]
    ds_read_b64_tr_b16 v[58:59], v244 offset:2560
    ds_read_b64_tr_b16 v[60:61], v245 offset:2048
    ds_read_b64_tr_b16 v[62:63], v245 offset:2560
    v_rcp_f32 v199, v199
    v_mul_f32 v77, v77, v197
    s_waitcnt lgkmcnt(12)
    v_mfma_f32_32x32x16_bf16 v[128:143], v[24:27], v[16:19], v[128:143]
    s_add_u32 s81, s81, 16384
    s_cmp_eq_u32 s81, 114688
    s_cselect_b32 s81, 0, s81
    v_add_u32 v223, 0x1c000, v221
    v_add_u32 v224, 0x1c000, v222
    v_xor_b32 v233, s81, v232
    v_xor_b32 v234, 32, v233
    v_mfma_f32_32x32x16_bf16 v[144:159], v[24:27], v[20:23], v[144:159]
    s_waitcnt lgkmcnt(0)
    s_barrier
    v_mfma_f32_32x32x16_bf16 v[160:175], v[28:31], v[16:19], v[160:175]
    v_mul_f32 v78, v78, v198
    v_mul_f32 v79, v79, v199
    v_cvt_pk_bf16_f32 v200, v72, v73
    v_cvt_pk_bf16_f32 v201, v74, v75
    v_cvt_pk_bf16_f32 v202, v76, v77
    v_cvt_pk_bf16_f32 v203, v78, v79
    v_mfma_f32_32x32x16_bf16 v[176:191], v[28:31], v[20:23], v[176:191]
    buffer_store_dwordx4 v[200:203], v250, s[52:55], s76 offen offset:0 sc1
    v_mul_f32 v192, v80, v80
    v_mul_f32 v193, v81, v81
    v_mul_f32 v194, v82, v82
    v_mul_f32 v195, v83, v83
    v_mfma_f32_32x32x16_bf16 v[128:143], v[40:43], v[32:35], v[128:143]
    ds_read_b128 v[0:3], v233 offset:0
    ds_read_b128 v[4:7], v233 offset:4096
    v_mul_f32 v196, v84, v84
    v_mul_f32 v197, v85, v85
    v_mul_f32 v198, v86, v86
    v_mul_f32 v199, v87, v87
    v_fma_f32 v192, v192, s94, v235
    v_mfma_f32_32x32x16_bf16 v[144:159], v[40:43], v[36:39], v[144:159]
    ds_read_b64_tr_b16 v[8:9], v223 offset:0
    ds_read_b64_tr_b16 v[10:11], v223 offset:512
    v_fma_f32 v193, v193, s94, v235
    v_fma_f32 v194, v194, s94, v235
    v_fma_f32 v195, v195, s94, v235
    v_fma_f32 v196, v196, s94, v235
    v_fma_f32 v197, v197, s94, v235
    v_mfma_f32_32x32x16_bf16 v[160:175], v[44:47], v[32:35], v[160:175]
    ds_read_b64_tr_b16 v[12:13], v224 offset:0
    ds_read_b64_tr_b16 v[14:15], v224 offset:512
    v_add_u32 v244, 0x2000, v223
    v_add_u32 v245, 0x2000, v224
    v_fma_f32 v198, v198, s94, v235
    v_fma_f32 v199, v199, s94, v235
    v_mul_f32 v192, v192, v80
    v_mfma_f32_32x32x16_bf16 v[176:191], v[44:47], v[36:39], v[176:191]
    ds_read_b128 v[16:19], v234 offset:0
    ds_read_b128 v[20:23], v234 offset:4096
    v_xor_b32 v246, 64, v233
    v_xor_b32 v247, 64, v234
    v_mul_f32 v193, v193, v81
    v_mul_f32 v194, v194, v82
    v_mul_f32 v195, v195, v83
    v_mfma_f32_32x32x16_bf16 v[128:143], v[56:59], v[48:51], v[128:143]
    ds_read_b64_tr_b16 v[24:25], v223 offset:2048
    ds_read_b64_tr_b16 v[26:27], v223 offset:2560
    v_mul_f32 v196, v196, v84
    v_mul_f32 v197, v197, v85
    v_mul_f32 v198, v198, v86
    v_mul_f32 v199, v199, v87
    v_mfma_f32_32x32x16_bf16 v[144:159], v[56:59], v[52:55], v[144:159]
    ds_read_b64_tr_b16 v[28:29], v224 offset:2048
    ds_read_b64_tr_b16 v[30:31], v224 offset:2560
    v_exp_f32 v192, v192
    v_mul_f32 v88, v88, v80
    v_exp_f32 v193, v193
    v_mfma_f32_32x32x16_bf16 v[160:175], v[60:63], v[48:51], v[160:175]
    v_mul_f32 v89, v89, v81
    v_exp_f32 v194, v194
    v_mul_f32 v90, v90, v82
    v_exp_f32 v195, v195
    v_mul_f32 v91, v91, v83
    v_mfma_f32_32x32x16_bf16 v[176:191], v[60:63], v[52:55], v[176:191]
    v_exp_f32 v196, v196
    v_mul_f32 v92, v92, v84
    v_exp_f32 v197, v197
    v_mul_f32 v93, v93, v85
    s_waitcnt lgkmcnt(8)
    v_mfma_f32_32x32x16_bf16 v[128:143], v[8:11], v[0:3], v[128:143]
    ds_read_b128 v[32:35], v246 offset:0
    ds_read_b128 v[36:39], v246 offset:4096
    ds_read_b64_tr_b16 v[40:41], v244 offset:0
    v_exp_f32 v198, v198
    v_mul_f32 v94, v94, v86
    v_mfma_f32_32x32x16_bf16 v[144:159], v[8:11], v[4:7], v[144:159]
    ds_read_b64_tr_b16 v[42:43], v244 offset:512
    ds_read_b64_tr_b16 v[44:45], v245 offset:0
    ds_read_b64_tr_b16 v[46:47], v245 offset:512
    v_exp_f32 v199, v199
    v_mul_f32 v95, v95, v87
    s_waitcnt lgkmcnt(12)
    v_mfma_f32_32x32x16_bf16 v[160:175], v[12:15], v[0:3], v[160:175]
    ds_read_b128 v[48:51], v247 offset:0
    ds_read_b128 v[52:55], v247 offset:4096
    ds_read_b64_tr_b16 v[56:57], v244 offset:2048
    v_fma_f32 v192, v192, v218, v218
    v_fma_f32 v193, v193, v218, v218
    v_fma_f32 v194, v194, v218, v218
    v_fma_f32 v195, v195, v218, v218
    v_mfma_f32_32x32x16_bf16 v[176:191], v[12:15], v[4:7], v[176:191]
    ds_read_b64_tr_b16 v[58:59], v244 offset:2560
    ds_read_b64_tr_b16 v[60:61], v245 offset:2048
    ds_read_b64_tr_b16 v[62:63], v245 offset:2560
    v_fma_f32 v196, v196, v218, v218
    v_fma_f32 v197, v197, v218, v218
    v_fma_f32 v198, v198, v218, v218
    s_waitcnt lgkmcnt(12)
    v_mfma_f32_32x32x16_bf16 v[128:143], v[24:27], v[16:19], v[128:143]
    s_add_u32 s81, s81, 16384
    s_cmp_eq_u32 s81, 114688
    s_cselect_b32 s81, 0, s81
    v_add_u32 v223, 0x20000, v221
    v_add_u32 v224, 0x20000, v222
    v_xor_b32 v233, s81, v232
    v_xor_b32 v234, 32, v233
    v_mfma_f32_32x32x16_bf16 v[144:159], v[24:27], v[20:23], v[144:159]
    s_waitcnt lgkmcnt(0)
    s_barrier
    v_mfma_f32_32x32x16_bf16 v[160:175], v[28:31], v[16:19], v[160:175]
    v_fma_f32 v199, v199, v218, v218
    v_rcp_f32 v192, v192
    v_rcp_f32 v193, v193
    v_rcp_f32 v194, v194
    v_mfma_f32_32x32x16_bf16 v[176:191], v[28:31], v[20:23], v[176:191]
    v_mul_f32 v88, v88, v192
    v_rcp_f32 v195, v195
    v_mul_f32 v89, v89, v193
    v_rcp_f32 v196, v196
    v_mul_f32 v90, v90, v194
    v_mfma_f32_32x32x16_bf16 v[128:143], v[40:43], v[32:35], v[128:143]
    ds_read_b128 v[0:3], v233 offset:0
    ds_read_b128 v[4:7], v233 offset:4096
    v_rcp_f32 v197, v197
    v_mul_f32 v91, v91, v195
    v_rcp_f32 v198, v198
    v_mfma_f32_32x32x16_bf16 v[144:159], v[40:43], v[36:39], v[144:159]
    ds_read_b64_tr_b16 v[8:9], v223 offset:0
    ds_read_b64_tr_b16 v[10:11], v223 offset:512
    v_mul_f32 v92, v92, v196
    v_rcp_f32 v199, v199
    v_mul_f32 v93, v93, v197
    v_mul_f32 v94, v94, v198
    v_mfma_f32_32x32x16_bf16 v[160:175], v[44:47], v[32:35], v[160:175]
    ds_read_b64_tr_b16 v[12:13], v224 offset:0
    ds_read_b64_tr_b16 v[14:15], v224 offset:512
    v_add_u32 v244, 0x2000, v223
    v_add_u32 v245, 0x2000, v224
    v_mul_f32 v95, v95, v199
    v_cvt_pk_bf16_f32 v204, v88, v89
    v_cvt_pk_bf16_f32 v205, v90, v91
    v_mfma_f32_32x32x16_bf16 v[176:191], v[44:47], v[36:39], v[176:191]
    ds_read_b128 v[16:19], v234 offset:0
    ds_read_b128 v[20:23], v234 offset:4096
    v_xor_b32 v246, 64, v233
    v_xor_b32 v247, 64, v234
    v_cvt_pk_bf16_f32 v206, v92, v93
    v_cvt_pk_bf16_f32 v207, v94, v95
    v_mfma_f32_32x32x16_bf16 v[128:143], v[56:59], v[48:51], v[128:143]
    ds_read_b64_tr_b16 v[24:25], v223 offset:2048
    ds_read_b64_tr_b16 v[26:27], v223 offset:2560
    buffer_store_dwordx4 v[204:207], v250, s[52:55], s78 offen offset:0 sc1
    v_mul_f32 v192, v96, v96
    v_mul_f32 v193, v97, v97
    v_mfma_f32_32x32x16_bf16 v[144:159], v[56:59], v[52:55], v[144:159]
    ds_read_b64_tr_b16 v[28:29], v224 offset:2048
    ds_read_b64_tr_b16 v[30:31], v224 offset:2560
    v_mul_f32 v194, v98, v98
    v_mul_f32 v195, v99, v99
    v_mul_f32 v196, v100, v100
    v_mul_f32 v197, v101, v101
    v_mul_f32 v198, v102, v102
    v_mfma_f32_32x32x16_bf16 v[160:175], v[60:63], v[48:51], v[160:175]
    v_mul_f32 v199, v103, v103
    v_fma_f32 v192, v192, s94, v235
    v_fma_f32 v193, v193, s94, v235
    v_fma_f32 v194, v194, s94, v235
    v_fma_f32 v195, v195, s94, v235
    v_fma_f32 v196, v196, s94, v235
    v_fma_f32 v197, v197, s94, v235
    v_mfma_f32_32x32x16_bf16 v[176:191], v[60:63], v[52:55], v[176:191]
    v_fma_f32 v198, v198, s94, v235
    v_fma_f32 v199, v199, s94, v235
    v_mul_f32 v192, v192, v96
    v_mul_f32 v193, v193, v97
    v_mul_f32 v194, v194, v98
    v_mul_f32 v195, v195, v99
    v_mul_f32 v196, v196, v100
    s_waitcnt lgkmcnt(8)
    v_mfma_f32_32x32x16_bf16 v[128:143], v[8:11], v[0:3], v[128:143]
    ds_read_b128 v[32:35], v246 offset:0
    ds_read_b128 v[36:39], v246 offset:4096
    ds_read_b64_tr_b16 v[40:41], v244 offset:0
    v_mul_f32 v197, v197, v101
    v_mul_f32 v198, v198, v102
    v_mul_f32 v199, v199, v103
    v_mfma_f32_32x32x16_bf16 v[144:159], v[8:11], v[4:7], v[144:159]
    ds_read_b64_tr_b16 v[42:43], v244 offset:512
    ds_read_b64_tr_b16 v[44:45], v245 offset:0
    ds_read_b64_tr_b16 v[46:47], v245 offset:512
    v_exp_f32 v192, v192
    v_mul_f32 v104, v104, v96
    s_waitcnt lgkmcnt(12)
    v_mfma_f32_32x32x16_bf16 v[160:175], v[12:15], v[0:3], v[160:175]
    ds_read_b128 v[48:51], v247 offset:0
    ds_read_b128 v[52:55], v247 offset:4096
    ds_read_b64_tr_b16 v[56:57], v244 offset:2048
    v_exp_f32 v193, v193
    v_mul_f32 v105, v105, v97
    v_mfma_f32_32x32x16_bf16 v[176:191], v[12:15], v[4:7], v[176:191]
    ds_read_b64_tr_b16 v[58:59], v244 offset:2560
    ds_read_b64_tr_b16 v[60:61], v245 offset:2048
    ds_read_b64_tr_b16 v[62:63], v245 offset:2560
    v_exp_f32 v194, v194
    v_mul_f32 v106, v106, v98
    s_waitcnt lgkmcnt(12)
    v_mfma_f32_32x32x16_bf16 v[128:143], v[24:27], v[16:19], v[128:143]
    s_add_u32 s81, s81, 16384
    s_cmp_eq_u32 s81, 114688
    s_cselect_b32 s81, 0, s81
    v_add_u32 v223, 0x24000, v221
    v_add_u32 v224, 0x24000, v222
    v_xor_b32 v233, s81, v232
    v_xor_b32 v234, 32, v233
    v_mfma_f32_32x32x16_bf16 v[144:159], v[24:27], v[20:23], v[144:159]
    s_waitcnt lgkmcnt(0)
    s_barrier
    v_mfma_f32_32x32x16_bf16 v[160:175], v[28:31], v[16:19], v[160:175]
    v_exp_f32 v195, v195
    v_mul_f32 v107, v107, v99
    v_exp_f32 v196, v196
    v_mul_f32 v108, v108, v100
    v_mfma_f32_32x32x16_bf16 v[176:191], v[28:31], v[20:23], v[176:191]
    v_exp_f32 v197, v197
    v_mul_f32 v109, v109, v101
    v_exp_f32 v198, v198
    v_mul_f32 v110, v110, v102
    v_mfma_f32_32x32x16_bf16 v[128:143], v[40:43], v[32:35], v[128:143]
    ds_read_b128 v[0:3], v233 offset:0
    ds_read_b128 v[4:7], v233 offset:4096
    v_exp_f32 v199, v199
    v_mul_f32 v111, v111, v103
    v_fma_f32 v192, v192, v216, v216
    v_fma_f32 v193, v193, v216, v216
    v_mfma_f32_32x32x16_bf16 v[144:159], v[40:43], v[36:39], v[144:159]
    ds_read_b64_tr_b16 v[8:9], v223 offset:0
    ds_read_b64_tr_b16 v[10:11], v223 offset:512
    v_fma_f32 v194, v194, v216, v216
    v_fma_f32 v195, v195, v216, v216
    v_fma_f32 v196, v196, v216, v216
    v_fma_f32 v197, v197, v216, v216
    v_fma_f32 v198, v198, v216, v216
    v_mfma_f32_32x32x16_bf16 v[160:175], v[44:47], v[32:35], v[160:175]
    ds_read_b64_tr_b16 v[12:13], v224 offset:0
    ds_read_b64_tr_b16 v[14:15], v224 offset:512
    v_add_u32 v244, 0x2000, v223
    v_add_u32 v245, 0x2000, v224
    v_fma_f32 v199, v199, v216, v216
    v_rcp_f32 v192, v192
    v_mfma_f32_32x32x16_bf16 v[176:191], v[44:47], v[36:39], v[176:191]
    ds_read_b128 v[16:19], v234 offset:0
    ds_read_b128 v[20:23], v234 offset:4096
    v_xor_b32 v246, 64, v233
    v_xor_b32 v247, 64, v234
    v_rcp_f32 v193, v193
    v_mfma_f32_32x32x16_bf16 v[128:143], v[56:59], v[48:51], v[128:143]
    ds_read_b64_tr_b16 v[24:25], v223 offset:2048
    ds_read_b64_tr_b16 v[26:27], v223 offset:2560
    v_rcp_f32 v194, v194
    v_mul_f32 v104, v104, v192
    v_rcp_f32 v195, v195
    v_mfma_f32_32x32x16_bf16 v[144:159], v[56:59], v[52:55], v[144:159]
    ds_read_b64_tr_b16 v[28:29], v224 offset:2048
    ds_read_b64_tr_b16 v[30:31], v224 offset:2560
    v_mul_f32 v105, v105, v193
    v_rcp_f32 v196, v196
    v_mul_f32 v106, v106, v194
    v_mfma_f32_32x32x16_bf16 v[160:175], v[60:63], v[48:51], v[160:175]
    v_rcp_f32 v197, v197
    v_mul_f32 v107, v107, v195
    v_rcp_f32 v198, v198
    v_mul_f32 v108, v108, v196
    v_mfma_f32_32x32x16_bf16 v[176:191], v[60:63], v[52:55], v[176:191]
    v_rcp_f32 v199, v199
    v_mul_f32 v109, v109, v197
    v_mul_f32 v110, v110, v198
    v_mul_f32 v111, v111, v199
    v_cvt_pk_bf16_f32 v208, v104, v105
    v_cvt_pk_bf16_f32 v209, v106, v107
    s_waitcnt lgkmcnt(8)
    v_mfma_f32_32x32x16_bf16 v[128:143], v[8:11], v[0:3], v[128:143]
    ds_read_b128 v[32:35], v246 offset:0
    ds_read_b128 v[36:39], v246 offset:4096
    ds_read_b64_tr_b16 v[40:41], v244 offset:0
    v_cvt_pk_bf16_f32 v210, v108, v109
    v_cvt_pk_bf16_f32 v211, v110, v111
    v_mfma_f32_32x32x16_bf16 v[144:159], v[8:11], v[4:7], v[144:159]
    ds_read_b64_tr_b16 v[42:43], v244 offset:512
    ds_read_b64_tr_b16 v[44:45], v245 offset:0
    ds_read_b64_tr_b16 v[46:47], v245 offset:512
    buffer_store_dwordx4 v[208:211], v250, s[52:55], s76 offen offset:1024 sc1
    s_waitcnt lgkmcnt(12)
    v_mfma_f32_32x32x16_bf16 v[160:175], v[12:15], v[0:3], v[160:175]
    ds_read_b128 v[48:51], v247 offset:0
    ds_read_b128 v[52:55], v247 offset:4096
    ds_read_b64_tr_b16 v[56:57], v244 offset:2048
    v_mul_f32 v192, v112, v112
    v_mul_f32 v193, v113, v113
    v_mul_f32 v194, v114, v114
    v_mul_f32 v195, v115, v115
    v_mfma_f32_32x32x16_bf16 v[176:191], v[12:15], v[4:7], v[176:191]
    ds_read_b64_tr_b16 v[58:59], v244 offset:2560
    ds_read_b64_tr_b16 v[60:61], v245 offset:2048
    ds_read_b64_tr_b16 v[62:63], v245 offset:2560
    v_mul_f32 v196, v116, v116
    v_mul_f32 v197, v117, v117
    v_mul_f32 v198, v118, v118
    s_waitcnt lgkmcnt(12)
    v_mfma_f32_32x32x16_bf16 v[128:143], v[24:27], v[16:19], v[128:143]
    s_add_u32 s81, s81, 16384
    s_cmp_eq_u32 s81, 114688
    s_cselect_b32 s81, 0, s81
    v_add_u32 v223, 0x1c000, v221
    v_add_u32 v224, 0x1c000, v222
    v_xor_b32 v233, s81, v232
    v_xor_b32 v234, 32, v233
    v_mfma_f32_32x32x16_bf16 v[144:159], v[24:27], v[20:23], v[144:159]
    s_waitcnt lgkmcnt(0)
    s_barrier
    v_mfma_f32_32x32x16_bf16 v[160:175], v[28:31], v[16:19], v[160:175]
    v_mul_f32 v199, v119, v119
    v_fma_f32 v192, v192, s94, v235
    v_fma_f32 v193, v193, s94, v235
    v_fma_f32 v194, v194, s94, v235
    v_fma_f32 v195, v195, s94, v235
    v_fma_f32 v196, v196, s94, v235
    v_fma_f32 v197, v197, s94, v235
    v_mfma_f32_32x32x16_bf16 v[176:191], v[28:31], v[20:23], v[176:191]
    v_fma_f32 v198, v198, s94, v235
    v_fma_f32 v199, v199, s94, v235
    v_mul_f32 v192, v192, v112
    v_mul_f32 v193, v193, v113
    v_mul_f32 v194, v194, v114
    v_mul_f32 v195, v195, v115
    v_mul_f32 v196, v196, v116
    v_mfma_f32_32x32x16_bf16 v[128:143], v[40:43], v[32:35], v[128:143]
    ds_read_b128 v[0:3], v233 offset:0
    ds_read_b128 v[4:7], v233 offset:4096
    v_mul_f32 v197, v197, v117
    v_mul_f32 v198, v198, v118
    v_mul_f32 v199, v199, v119
    v_exp_f32 v192, v192
    v_mfma_f32_32x32x16_bf16 v[144:159], v[40:43], v[36:39], v[144:159]
    ds_read_b64_tr_b16 v[8:9], v223 offset:0
    ds_read_b64_tr_b16 v[10:11], v223 offset:512
    v_mul_f32 v120, v120, v112
    v_exp_f32 v193, v193
    v_mul_f32 v121, v121, v113
    v_mfma_f32_32x32x16_bf16 v[160:175], v[44:47], v[32:35], v[160:175]
    ds_read_b64_tr_b16 v[12:13], v224 offset:0
    ds_read_b64_tr_b16 v[14:15], v224 offset:512
    v_add_u32 v244, 0x2000, v223
    v_add_u32 v245, 0x2000, v224
    v_exp_f32 v194, v194
    v_mul_f32 v122, v122, v114
    v_mfma_f32_32x32x16_bf16 v[176:191], v[44:47], v[36:39], v[176:191]
    ds_read_b128 v[16:19], v234 offset:0
    ds_read_b128 v[20:23], v234 offset:4096
    v_xor_b32 v246, 64, v233
    v_xor_b32 v247, 64, v234
    v_exp_f32 v195, v195
    v_mul_f32 v123, v123, v115
    v_mfma_f32_32x32x16_bf16 v[128:143], v[56:59], v[48:51], v[128:143]
    ds_read_b64_tr_b16 v[24:25], v223 offset:2048
    ds_read_b64_tr_b16 v[26:27], v223 offset:2560
    v_exp_f32 v196, v196
    v_mul_f32 v124, v124, v116
    v_exp_f32 v197, v197
    v_mfma_f32_32x32x16_bf16 v[144:159], v[56:59], v[52:55], v[144:159]
    ds_read_b64_tr_b16 v[28:29], v224 offset:2048
    ds_read_b64_tr_b16 v[30:31], v224 offset:2560
    v_mul_f32 v125, v125, v117
    v_exp_f32 v198, v198
    v_mul_f32 v126, v126, v118
    v_mfma_f32_32x32x16_bf16 v[160:175], v[60:63], v[48:51], v[160:175]
    v_exp_f32 v199, v199
    v_mul_f32 v127, v127, v119
    v_fma_f32 v192, v192, v218, v218
    v_fma_f32 v193, v193, v218, v218
    v_fma_f32 v194, v194, v218, v218
    v_fma_f32 v195, v195, v218, v218
    v_mfma_f32_32x32x16_bf16 v[176:191], v[60:63], v[52:55], v[176:191]
    v_fma_f32 v196, v196, v218, v218
    v_fma_f32 v197, v197, v218, v218
    v_fma_f32 v198, v198, v218, v218
    v_fma_f32 v199, v199, v218, v218
    v_rcp_f32 v192, v192
    s_waitcnt lgkmcnt(8)
    v_mfma_f32_32x32x16_bf16 v[128:143], v[8:11], v[0:3], v[128:143]
    ds_read_b128 v[32:35], v246 offset:0
    ds_read_b128 v[36:39], v246 offset:4096
    ds_read_b64_tr_b16 v[40:41], v244 offset:0
    v_rcp_f32 v193, v193
    v_rcp_f32 v194, v194
    v_mfma_f32_32x32x16_bf16 v[144:159], v[8:11], v[4:7], v[144:159]
    ds_read_b64_tr_b16 v[42:43], v244 offset:512
    ds_read_b64_tr_b16 v[44:45], v245 offset:0
    ds_read_b64_tr_b16 v[46:47], v245 offset:512
    v_mul_f32 v120, v120, v192
    v_rcp_f32 v195, v195
    s_waitcnt lgkmcnt(12)
    v_mfma_f32_32x32x16_bf16 v[160:175], v[12:15], v[0:3], v[160:175]
    ds_read_b128 v[48:51], v247 offset:0
    ds_read_b128 v[52:55], v247 offset:4096
    ds_read_b64_tr_b16 v[56:57], v244 offset:2048
    v_mul_f32 v121, v121, v193
    v_rcp_f32 v196, v196
    v_mul_f32 v122, v122, v194
    v_mfma_f32_32x32x16_bf16 v[176:191], v[12:15], v[4:7], v[176:191]
    ds_read_b64_tr_b16 v[58:59], v244 offset:2560
    ds_read_b64_tr_b16 v[60:61], v245 offset:2048
    ds_read_b64_tr_b16 v[62:63], v245 offset:2560
    v_rcp_f32 v197, v197
    v_mul_f32 v123, v123, v195
    s_waitcnt lgkmcnt(12)
    v_mfma_f32_32x32x16_bf16 v[128:143], v[24:27], v[16:19], v[128:143]
    s_add_u32 s81, s81, 16384
    s_cmp_eq_u32 s81, 114688
    s_cselect_b32 s81, 0, s81
    v_add_u32 v223, 0x20000, v221
    v_add_u32 v224, 0x20000, v222
    v_xor_b32 v233, s81, v232
    v_xor_b32 v234, 32, v233
    v_mfma_f32_32x32x16_bf16 v[144:159], v[24:27], v[20:23], v[144:159]
    s_waitcnt lgkmcnt(0)
    s_barrier
    v_mfma_f32_32x32x16_bf16 v[160:175], v[28:31], v[16:19], v[160:175]
    v_rcp_f32 v198, v198
    v_mul_f32 v124, v124, v196
    v_rcp_f32 v199, v199
    v_mul_f32 v125, v125, v197
    v_mul_f32 v126, v126, v198
    v_mfma_f32_32x32x16_bf16 v[176:191], v[28:31], v[20:23], v[176:191]
    v_mul_f32 v127, v127, v199
    v_cvt_pk_bf16_f32 v212, v120, v121
    v_cvt_pk_bf16_f32 v213, v122, v123
    v_cvt_pk_bf16_f32 v214, v124, v125
    v_cvt_pk_bf16_f32 v215, v126, v127
    v_mfma_f32_32x32x16_bf16 v[128:143], v[40:43], v[32:35], v[128:143]
    ds_read_b128 v[0:3], v233 offset:0
    ds_read_b128 v[4:7], v233 offset:4096
    buffer_store_dwordx4 v[212:215], v250, s[52:55], s78 offen offset:1024 sc1
    v_mfma_f32_32x32x16_bf16 v[144:159], v[40:43], v[36:39], v[144:159]
    ds_read_b64_tr_b16 v[8:9], v223 offset:0
    ds_read_b64_tr_b16 v[10:11], v223 offset:512
    v_mfma_f32_32x32x16_bf16 v[160:175], v[44:47], v[32:35], v[160:175]
    ds_read_b64_tr_b16 v[12:13], v224 offset:0
    ds_read_b64_tr_b16 v[14:15], v224 offset:512
    v_add_u32 v244, 0x2000, v223
    v_add_u32 v245, 0x2000, v224
    v_mfma_f32_32x32x16_bf16 v[176:191], v[44:47], v[36:39], v[176:191]
    ds_read_b128 v[16:19], v234 offset:0
    ds_read_b128 v[20:23], v234 offset:4096
    v_xor_b32 v246, 64, v233
    v_xor_b32 v247, 64, v234
    v_mfma_f32_32x32x16_bf16 v[128:143], v[56:59], v[48:51], v[128:143]
    ds_read_b64_tr_b16 v[24:25], v223 offset:2048
    ds_read_b64_tr_b16 v[26:27], v223 offset:2560
    v_mfma_f32_32x32x16_bf16 v[144:159], v[56:59], v[52:55], v[144:159]
    ds_read_b64_tr_b16 v[28:29], v224 offset:2048
    ds_read_b64_tr_b16 v[30:31], v224 offset:2560
    v_mfma_f32_32x32x16_bf16 v[160:175], v[60:63], v[48:51], v[160:175]
    v_mfma_f32_32x32x16_bf16 v[176:191], v[60:63], v[52:55], v[176:191]
    s_waitcnt lgkmcnt(8)
    v_mfma_f32_32x32x16_bf16 v[128:143], v[8:11], v[0:3], v[128:143]
    ds_read_b128 v[32:35], v246 offset:0
    ds_read_b128 v[36:39], v246 offset:4096
    ds_read_b64_tr_b16 v[40:41], v244 offset:0
    v_mfma_f32_32x32x16_bf16 v[144:159], v[8:11], v[4:7], v[144:159]
    ds_read_b64_tr_b16 v[42:43], v244 offset:512
    ds_read_b64_tr_b16 v[44:45], v245 offset:0
    ds_read_b64_tr_b16 v[46:47], v245 offset:512
    s_waitcnt lgkmcnt(12)
    v_mfma_f32_32x32x16_bf16 v[160:175], v[12:15], v[0:3], v[160:175]
    ds_read_b128 v[48:51], v247 offset:0
    ds_read_b128 v[52:55], v247 offset:4096
    ds_read_b64_tr_b16 v[56:57], v244 offset:2048
    v_mfma_f32_32x32x16_bf16 v[176:191], v[12:15], v[4:7], v[176:191]
    ds_read_b64_tr_b16 v[58:59], v244 offset:2560
    ds_read_b64_tr_b16 v[60:61], v245 offset:2048
    ds_read_b64_tr_b16 v[62:63], v245 offset:2560
    s_waitcnt lgkmcnt(12)
    v_mfma_f32_32x32x16_bf16 v[128:143], v[24:27], v[16:19], v[128:143]
    v_mfma_f32_32x32x16_bf16 v[144:159], v[24:27], v[20:23], v[144:159]
    s_waitcnt lgkmcnt(0)
    s_barrier
    v_mfma_f32_32x32x16_bf16 v[160:175], v[28:31], v[16:19], v[160:175]
    v_mfma_f32_32x32x16_bf16 v[176:191], v[28:31], v[20:23], v[176:191]
    v_mfma_f32_32x32x16_bf16 v[128:143], v[40:43], v[32:35], v[128:143]
    s_mov_b32 s60, s20
    s_mov_b32 s61, s21
    s_mov_b32 s62, 0x62000
    s_mov_b32 s63, 0x20000
    s_lshr_b32 s11, s10, 1
    s_xor_b32 s11, s11, s2
    s_and_b32 s11, s11, 1
    s_lshr_b32 s12, s2, 3
    s_mul_i32 s38, s11, 32
    s_add_u32 s38, s38, s12
    s_mul_i32 s13, s38, 147
    v_mfma_f32_32x32x16_bf16 v[144:159], v[40:43], v[36:39], v[144:159]
    s_lshr_b32 s13, s13, 10
    s_mul_i32 s9, s13, 7
    s_sub_u32 s9, s38, s9
    s_bfe_u32 s38, s2, 0x20001
    s_lshl_b32 s38, s38, 3
    s_add_u32 s8, s38, s13
    s_mul_i32 s11, s11, 8
    s_add_u32 s12, s12, s11
    s_cmp_lt_u32 s12, 32
    s_cselect_b32 s88, 1, 0
    s_mov_b32 s56, s28
    v_mfma_f32_32x32x16_bf16 v[160:175], v[44:47], v[32:35], v[160:175]
    s_mov_b32 s57, s29
    s_mov_b32 s58, 0x188000
    s_mov_b32 s59, 0x20000
    v_lshrrev_b32 v16, 3, v251
    v_and_b32 v17, 7, v251
    v_bfe_u32 v18, v16, 1, 1
    v_lshlrev_b32 v18, 2, v18
    v_xor_b32 v18, v18, v17
    v_lshlrev_b32 v18, 4, v18
    v_mul_u32_u24 v16, 896, v16
    s_lshl_b32 s11, s9, 7
    v_mfma_f32_32x32x16_bf16 v[176:191], v[44:47], v[36:39], v[176:191]
    v_add3_u32 v226, v16, v18, s11
    s_and_b32 s12, s3, 3
    s_mul_i32 s22, s12, 401408
    s_add_u32 s77, s22, 401408
    s_lshl_b32 s84, s9, 2
    s_and_b32 s11, s8, 3
    s_add_u32 s84, s84, s11
    s_mul_i32 s11, s84, 14336
    s_add_u32 s0, s22, s11
    s_cmp_eq_u32 s88, 0
    s_cselect_b32 s0, 0x40000000, s0
    v_mfma_f32_32x32x16_bf16 v[128:143], v[56:59], v[48:51], v[128:143]
    s_mul_i32 s1, s12, 26624
    s_add_u32 s1, s1, 49152
    s_and_b32 s12, s3, 3
    s_mul_i32 s13, s12, 26624
    s_add_u32 s13, s13, 49152
    v_bfe_u32 v240, v251, 2, 2
    v_lshrrev_b32 v243, 5, v251
    v_lshl_add_u32 v243, v243, 2, v240
    v_lshl_add_u32 v243, v243, 7, s13
    v_lshrrev_b32 v240, 1, v240
    v_lshlrev_b32 v240, 6, v240
    v_mfma_f32_32x32x16_bf16 v[144:159], v[56:59], v[52:55], v[144:159]
    v_bfe_u32 v244, v251, 4, 1
    v_add_u32 v244, s12, v244
    v_and_b32 v245, 3, v251
    v_lshlrev_b32 v245, 3, v245
    v_add_u32 v246, 0, v244
    v_and_b32 v246, 3, v246
    v_lshl_add_u32 v246, v246, 5, v245
    v_xor_b32 v246, v246, v240
    v_add_u32 v227, v246, v243
    v_add_u32 v246, 2, v244
    v_and_b32 v246, 3, v246
    v_mfma_f32_32x32x16_bf16 v[160:175], v[60:63], v[48:51], v[160:175]
    v_lshl_add_u32 v246, v246, 5, v245
    v_xor_b32 v246, v246, v240
    v_add_u32 v228, v246, v243
    s_lshl_b32 s11, s8, 2
    s_add_u32 s11, s11, s12
    s_mul_i32 s11, s11, 1792
    s_add_u32 s11, s11, 0xf40000
    v_min_u32 v240, 13, v251
    v_lshl_add_u32 v248, v240, 7, s11
    s_mul_i32 s11, s8, 229376
    s_mul_i32 s13, s12, 28672
    v_mfma_f32_32x32x16_bf16 v[176:191], v[60:63], v[52:55], v[176:191]
    s_add_u32 s11, s11, s13
    s_add_u32 s11, s11, 0x600000
    v_add_u32 v225, s11, v250
    s_lshl_b32 s73, s84, 10
    s_mul_i32 s23, s12, 100352
    v_add_u32 v229, 114688, v225
    s_nop 8
    v_mul_f32 v192, v128, v128
    v_mul_f32 v193, v129, v129
    v_mul_f32 v194, v130, v130
    v_mul_f32 v195, v131, v131
    v_mul_f32 v196, v132, v132
    v_mul_f32 v197, v133, v133
    v_mul_f32 v198, v134, v134
    v_mul_f32 v199, v135, v135
    v_fma_f32 v192, v192, s94, v235
    v_fma_f32 v193, v193, s94, v235
    v_fma_f32 v194, v194, s94, v235
    v_fma_f32 v195, v195, s94, v235
    v_fma_f32 v196, v196, s94, v235
    v_fma_f32 v197, v197, s94, v235
    v_fma_f32 v198, v198, s94, v235
    v_fma_f32 v199, v199, s94, v235
    v_mul_f32 v192, v192, v128
    v_mul_f32 v193, v193, v129
    v_mul_f32 v194, v194, v130
    v_mul_f32 v195, v195, v131
    v_mul_f32 v196, v196, v132
    v_mul_f32 v197, v197, v133
    v_mul_f32 v198, v198, v134
    v_mul_f32 v199, v199, v135
    v_exp_f32 v192, v192
    v_mul_f32 v136, v136, v128
    v_exp_f32 v193, v193
    v_mul_f32 v137, v137, v129
    v_exp_f32 v194, v194
    v_mul_f32 v138, v138, v130
    v_exp_f32 v195, v195
    v_mul_f32 v139, v139, v131
    v_exp_f32 v196, v196
    v_mul_f32 v140, v140, v132
    v_exp_f32 v197, v197
    v_mul_f32 v141, v141, v133
    v_exp_f32 v198, v198
    v_mul_f32 v142, v142, v134
    v_exp_f32 v199, v199
    v_mul_f32 v143, v143, v135
    v_fma_f32 v192, v192, v216, v216
    v_fma_f32 v193, v193, v216, v216
    v_fma_f32 v194, v194, v216, v216
    v_fma_f32 v195, v195, v216, v216
    v_fma_f32 v196, v196, v216, v216
    v_fma_f32 v197, v197, v216, v216
    v_fma_f32 v198, v198, v216, v216
    v_fma_f32 v199, v199, v216, v216
    v_rcp_f32 v192, v192
    v_rcp_f32 v193, v193
    v_rcp_f32 v194, v194
    v_mul_f32 v136, v136, v192
    v_rcp_f32 v195, v195
    v_mul_f32 v137, v137, v193
    v_rcp_f32 v196, v196
    v_mul_f32 v138, v138, v194
    v_rcp_f32 v197, v197
    v_mul_f32 v139, v139, v195
    v_rcp_f32 v198, v198
    v_mul_f32 v140, v140, v196
    v_rcp_f32 v199, v199
    v_mul_f32 v141, v141, v197
    v_mul_f32 v142, v142, v198
    v_mul_f32 v143, v143, v199
    v_cvt_pk_bf16_f32 v200, v136, v137
    v_cvt_pk_bf16_f32 v201, v138, v139
    v_cvt_pk_bf16_f32 v202, v140, v141
    v_cvt_pk_bf16_f32 v203, v142, v143
    s_waitcnt vmcnt(0)
    s_mov_b64 exec, 1
    buffer_store_dword v242, v249, s[52:55], 0 offen sc1
    s_mov_b64 exec, -1
    v_add_u32 v249, 256, v249
    s_add_u32 s76, s76, 4096
    s_add_u32 s78, s78, 4096
    buffer_store_dwordx4 v[200:203], v250, s[52:55], s76 offen offset:0 sc1
    v_mul_f32 v192, v144, v144
    v_mul_f32 v193, v145, v145
    v_mul_f32 v194, v146, v146
    v_mul_f32 v195, v147, v147
    v_mul_f32 v196, v148, v148
    v_mul_f32 v197, v149, v149
    v_mul_f32 v198, v150, v150
    v_mul_f32 v199, v151, v151
    v_fma_f32 v192, v192, s94, v235
    v_fma_f32 v193, v193, s94, v235
    v_fma_f32 v194, v194, s94, v235
    v_fma_f32 v195, v195, s94, v235
    v_fma_f32 v196, v196, s94, v235
    v_fma_f32 v197, v197, s94, v235
    v_fma_f32 v198, v198, s94, v235
    v_fma_f32 v199, v199, s94, v235
    v_mul_f32 v192, v192, v144
    v_mul_f32 v193, v193, v145
    v_mul_f32 v194, v194, v146
    v_mul_f32 v195, v195, v147
    v_mul_f32 v196, v196, v148
    v_mul_f32 v197, v197, v149
    v_mul_f32 v198, v198, v150
    v_mul_f32 v199, v199, v151
    v_exp_f32 v192, v192
    v_mul_f32 v152, v152, v144
    v_exp_f32 v193, v193
    v_mul_f32 v153, v153, v145
    v_exp_f32 v194, v194
    v_mul_f32 v154, v154, v146
    v_exp_f32 v195, v195
    v_mul_f32 v155, v155, v147
    v_exp_f32 v196, v196
    v_mul_f32 v156, v156, v148
    v_exp_f32 v197, v197
    v_mul_f32 v157, v157, v149
    v_exp_f32 v198, v198
    v_mul_f32 v158, v158, v150
    v_exp_f32 v199, v199
    v_mul_f32 v159, v159, v151
    v_fma_f32 v192, v192, v218, v218
    v_fma_f32 v193, v193, v218, v218
    v_fma_f32 v194, v194, v218, v218
    v_fma_f32 v195, v195, v218, v218
    v_fma_f32 v196, v196, v218, v218
    v_fma_f32 v197, v197, v218, v218
    v_fma_f32 v198, v198, v218, v218
    v_fma_f32 v199, v199, v218, v218
    v_rcp_f32 v192, v192
    v_rcp_f32 v193, v193
    v_rcp_f32 v194, v194
    v_mul_f32 v152, v152, v192
    v_rcp_f32 v195, v195
    v_mul_f32 v153, v153, v193
    v_rcp_f32 v196, v196
    v_mul_f32 v154, v154, v194
    v_rcp_f32 v197, v197
    v_mul_f32 v155, v155, v195
    v_rcp_f32 v198, v198
    v_mul_f32 v156, v156, v196
    v_rcp_f32 v199, v199
    v_mul_f32 v157, v157, v197
    v_mul_f32 v158, v158, v198
    v_mul_f32 v159, v159, v199
    v_cvt_pk_bf16_f32 v204, v152, v153
    v_cvt_pk_bf16_f32 v205, v154, v155
    v_cvt_pk_bf16_f32 v206, v156, v157
    v_cvt_pk_bf16_f32 v207, v158, v159
    buffer_store_dwordx4 v[204:207], v250, s[52:55], s78 offen offset:0 sc1
    v_mul_f32 v192, v160, v160
    v_mul_f32 v193, v161, v161
    v_mul_f32 v194, v162, v162
    v_mul_f32 v195, v163, v163
    v_mul_f32 v196, v164, v164
    v_mul_f32 v197, v165, v165
    v_mul_f32 v198, v166, v166
    v_mul_f32 v199, v167, v167
    v_fma_f32 v192, v192, s94, v235
    v_fma_f32 v193, v193, s94, v235
    v_fma_f32 v194, v194, s94, v235
    v_fma_f32 v195, v195, s94, v235
    v_fma_f32 v196, v196, s94, v235
    v_fma_f32 v197, v197, s94, v235
    v_fma_f32 v198, v198, s94, v235
    v_fma_f32 v199, v199, s94, v235
    v_mul_f32 v192, v192, v160
    v_mul_f32 v193, v193, v161
    v_mul_f32 v194, v194, v162
    v_mul_f32 v195, v195, v163
    v_mul_f32 v196, v196, v164
    v_mul_f32 v197, v197, v165
    v_mul_f32 v198, v198, v166
    v_mul_f32 v199, v199, v167
    v_exp_f32 v192, v192
    v_mul_f32 v168, v168, v160
    v_exp_f32 v193, v193
    v_mul_f32 v169, v169, v161
    v_exp_f32 v194, v194
    v_mul_f32 v170, v170, v162
    v_exp_f32 v195, v195
    v_mul_f32 v171, v171, v163
    v_exp_f32 v196, v196
    v_mul_f32 v172, v172, v164
    v_exp_f32 v197, v197
    v_mul_f32 v173, v173, v165
    v_exp_f32 v198, v198
    v_mul_f32 v174, v174, v166
    v_exp_f32 v199, v199
    v_mul_f32 v175, v175, v167
    v_fma_f32 v192, v192, v216, v216
    v_fma_f32 v193, v193, v216, v216
    v_fma_f32 v194, v194, v216, v216
    v_fma_f32 v195, v195, v216, v216
    v_fma_f32 v196, v196, v216, v216
    v_fma_f32 v197, v197, v216, v216
    v_fma_f32 v198, v198, v216, v216
    v_fma_f32 v199, v199, v216, v216
    v_rcp_f32 v192, v192
    v_rcp_f32 v193, v193
    v_rcp_f32 v194, v194
    v_mul_f32 v168, v168, v192
    v_rcp_f32 v195, v195
    v_mul_f32 v169, v169, v193
    v_rcp_f32 v196, v196
    v_mul_f32 v170, v170, v194
    v_rcp_f32 v197, v197
    v_mul_f32 v171, v171, v195
    v_rcp_f32 v198, v198
    v_mul_f32 v172, v172, v196
    v_rcp_f32 v199, v199
    v_mul_f32 v173, v173, v197
    v_mul_f32 v174, v174, v198
    v_mul_f32 v175, v175, v199
    v_cvt_pk_bf16_f32 v208, v168, v169
    v_cvt_pk_bf16_f32 v209, v170, v171
    v_cvt_pk_bf16_f32 v210, v172, v173
    v_cvt_pk_bf16_f32 v211, v174, v175
    buffer_store_dwordx4 v[208:211], v250, s[52:55], s76 offen offset:1024 sc1
    v_mul_f32 v192, v176, v176
    v_mul_f32 v193, v177, v177
    v_mul_f32 v194, v178, v178
    v_mul_f32 v195, v179, v179
    v_mul_f32 v196, v180, v180
    v_mul_f32 v197, v181, v181
    v_mul_f32 v198, v182, v182
    v_mul_f32 v199, v183, v183
    v_fma_f32 v192, v192, s94, v235
    v_fma_f32 v193, v193, s94, v235
    v_fma_f32 v194, v194, s94, v235
    v_fma_f32 v195, v195, s94, v235
    v_fma_f32 v196, v196, s94, v235
    v_fma_f32 v197, v197, s94, v235
    v_fma_f32 v198, v198, s94, v235
    v_fma_f32 v199, v199, s94, v235
    v_mul_f32 v192, v192, v176
    v_mul_f32 v193, v193, v177
    v_mul_f32 v194, v194, v178
    v_mul_f32 v195, v195, v179
    v_mul_f32 v196, v196, v180
    v_mul_f32 v197, v197, v181
    v_mul_f32 v198, v198, v182
    v_mul_f32 v199, v199, v183
    v_exp_f32 v192, v192
    v_mul_f32 v184, v184, v176
    v_exp_f32 v193, v193
    v_mul_f32 v185, v185, v177
    v_exp_f32 v194, v194
    v_mul_f32 v186, v186, v178
    v_exp_f32 v195, v195
    v_mul_f32 v187, v187, v179
    v_exp_f32 v196, v196
    v_mul_f32 v188, v188, v180
    v_exp_f32 v197, v197
    v_mul_f32 v189, v189, v181
    v_exp_f32 v198, v198
    v_mul_f32 v190, v190, v182
    v_exp_f32 v199, v199
    v_mul_f32 v191, v191, v183
    v_fma_f32 v192, v192, v218, v218
    v_fma_f32 v193, v193, v218, v218
    v_fma_f32 v194, v194, v218, v218
    v_fma_f32 v195, v195, v218, v218
    v_fma_f32 v196, v196, v218, v218
    v_fma_f32 v197, v197, v218, v218
    v_fma_f32 v198, v198, v218, v218
    v_fma_f32 v199, v199, v218, v218
    v_rcp_f32 v192, v192
    v_rcp_f32 v193, v193
    v_rcp_f32 v194, v194
    v_mul_f32 v184, v184, v192
    v_rcp_f32 v195, v195
    v_mul_f32 v185, v185, v193
    v_rcp_f32 v196, v196
    v_mul_f32 v186, v186, v194
    v_rcp_f32 v197, v197
    v_mul_f32 v187, v187, v195
    v_rcp_f32 v198, v198
    v_mul_f32 v188, v188, v196
    v_rcp_f32 v199, v199
    v_mul_f32 v189, v189, v197
    v_mul_f32 v190, v190, v198
    v_mul_f32 v191, v191, v199
    v_cvt_pk_bf16_f32 v212, v184, v185
    v_cvt_pk_bf16_f32 v213, v186, v187
    v_cvt_pk_bf16_f32 v214, v188, v189
    v_cvt_pk_bf16_f32 v215, v190, v191
    buffer_store_dwordx4 v[212:215], v250, s[52:55], s78 offen offset:1024 sc1
    s_setprio 0
    s_waitcnt vmcnt(0)
    s_mov_b64 exec, 1
    buffer_store_dword v242, v249, s[52:55], 0 offen sc1
    s_mov_b64 exec, -1
    s_cmp_eq_u32 s88, 0
    s_cbranch_scc1 Lexit
    s_add_u32 m0, s1, 0
    s_nop 0
    buffer_load_dwordx4 v226, s[56:59], s0 offen lds
    s_add_u32 s0, s0, 7168
    s_add_u32 m0, s1, 1024
    s_nop 0
    buffer_load_dwordx4 v226, s[56:59], s0 offen lds
    s_add_u32 s0, s0, 7168
    s_cmp_eq_u32 s0, s77
    s_cselect_b32 s0, s22, s0
    s_add_u32 m0, s1, 2048
    s_nop 0
    buffer_load_dwordx4 v226, s[56:59], s0 offen lds
    s_add_u32 s0, s0, 7168
    s_add_u32 m0, s1, 3072
    s_nop 0
    buffer_load_dwordx4 v226, s[56:59], s0 offen lds
    s_add_u32 s0, s0, 7168
    s_cmp_eq_u32 s0, s77
    s_cselect_b32 s0, s22, s0
    s_add_u32 m0, s1, 4096
    s_nop 0
    buffer_load_dwordx4 v226, s[56:59], s0 offen lds
    s_add_u32 s0, s0, 7168
    s_add_u32 m0, s1, 5120
    s_nop 0
    buffer_load_dwordx4 v226, s[56:59], s0 offen lds
    s_add_u32 s0, s0, 7168
    s_cmp_eq_u32 s0, s77
    s_cselect_b32 s0, s22, s0
    s_add_u32 m0, s1, 6144
    s_nop 0
    buffer_load_dwordx4 v226, s[56:59], s0 offen lds
    s_add_u32 s0, s0, 7168
    s_add_u32 m0, s1, 7168
    s_nop 0
    buffer_load_dwordx4 v226, s[56:59], s0 offen lds
    s_add_u32 s0, s0, 7168
    s_cmp_eq_u32 s0, s77
    s_cselect_b32 s0, s22, s0
    s_add_u32 m0, s1, 8192
    s_nop 0
    buffer_load_dwordx4 v226, s[56:59], s0 offen lds
    s_add_u32 s0, s0, 7168
    s_add_u32 m0, s1, 9216
    s_nop 0
    buffer_load_dwordx4 v226, s[56:59], s0 offen lds
    s_add_u32 s0, s0, 7168
    s_cmp_eq_u32 s0, s77
    s_cselect_b32 s0, s22, s0
    s_add_u32 m0, s1, 10240
    s_nop 0
    buffer_load_dwordx4 v226, s[56:59], s0 offen lds
    s_add_u32 s0, s0, 7168
    s_add_u32 m0, s1, 11264
    s_nop 0
    buffer_load_dwordx4 v226, s[56:59], s0 offen lds
    s_add_u32 s0, s0, 7168
    s_cmp_eq_u32 s0, s77
    s_cselect_b32 s0, s22, s0
    s_add_u32 m0, s1, 12288
    s_nop 0
    buffer_load_dwordx4 v226, s[56:59], s0 offen lds
    s_add_u32 s0, s0, 7168
    s_add_u32 m0, s1, 13312
    s_nop 0
    buffer_load_dwordx4 v226, s[56:59], s0 offen lds
    s_add_u32 s0, s0, 7168
    s_cmp_eq_u32 s0, s77
    s_cselect_b32 s0, s22, s0
    s_add_u32 m0, s1, 14336
    s_nop 0
    buffer_load_dwordx4 v226, s[56:59], s0 offen lds
    s_add_u32 s0, s0, 7168
    s_add_u32 m0, s1, 15360
    s_nop 0
    buffer_load_dwordx4 v226, s[56:59], s0 offen lds
    s_add_u32 s0, s0, 7168
    s_cmp_eq_u32 s0, s77
    s_cselect_b32 s0, s22, s0
    s_add_u32 m0, s1, 16384
    s_nop 0
    buffer_load_dwordx4 v226, s[56:59], s0 offen lds
    s_add_u32 s0, s0, 7168
    s_add_u32 m0, s1, 17408
    s_nop 0
    buffer_load_dwordx4 v226, s[56:59], s0 offen lds
    s_add_u32 s0, s0, 7168
    s_cmp_eq_u32 s0, s77
    s_cselect_b32 s0, s22, s0
    s_add_u32 m0, s1, 18432
    s_nop 0
    buffer_load_dwordx4 v226, s[56:59], s0 offen lds
    s_add_u32 s0, s0, 7168
    s_add_u32 m0, s1, 19456
    s_nop 0
    buffer_load_dwordx4 v226, s[56:59], s0 offen lds
    s_add_u32 s0, s0, 7168
    s_cmp_eq_u32 s0, s77
    s_cselect_b32 s0, s22, s0
    s_add_u32 m0, s1, 20480
    s_nop 0
    buffer_load_dwordx4 v226, s[56:59], s0 offen lds
    s_add_u32 s0, s0, 7168
    s_add_u32 m0, s1, 21504
    s_nop 0
    buffer_load_dwordx4 v226, s[56:59], s0 offen lds
    s_add_u32 s0, s0, 7168
    s_cmp_eq_u32 s0, s77
    s_cselect_b32 s0, s22, s0
    s_add_u32 m0, s1, 22528
    s_nop 0
    buffer_load_dwordx4 v226, s[56:59], s0 offen lds
    s_add_u32 s0, s0, 7168
    s_add_u32 m0, s1, 23552
    s_nop 0
    buffer_load_dwordx4 v226, s[56:59], s0 offen lds
    s_add_u32 s0, s0, 7168
    s_cmp_eq_u32 s0, s77
    s_cselect_b32 s0, s22, s0
    s_add_u32 m0, s1, 24576
    s_nop 0
    buffer_load_dwordx4 v226, s[56:59], s0 offen lds
    s_add_u32 s0, s0, 7168
    s_add_u32 m0, s1, 25600
    s_nop 0
    buffer_load_dwordx4 v226, s[56:59], s0 offen lds
    s_add_u32 s0, s0, 7168
    s_cmp_eq_u32 s0, s77
    s_cselect_b32 s0, s22, s0
    s_branch Ldown
Lgu_end_s:
    s_waitcnt vmcnt(0)
    s_barrier
    v_mfma_f32_32x32x16_bf16 v[64:79], v[40:43], v[32:35], v[64:79]
    s_mov_b32 s89, 1048576
Lge_n1:
    v_readfirstlane_b32 s10, v240
    s_nop 1
    s_cmp_lg_u32 s10, 0
    s_cbranch_scc1 Lge_n2
    s_sub_u32 s89, s89, 1
    s_cbranch_scc1 Lge_n2
    buffer_load_dword v240, v252, s[68:71], 0 offen sc1
    s_waitcnt vmcnt(0)
    s_branch Lge_n1
Lge_n2:
    v_mov_b32 v242, s10
    v_mfma_f32_32x32x16_bf16 v[80:95], v[40:43], v[36:39], v[80:95]
    s_lshl_b32 s76, s4, 1
    s_add_u32 s76, s76, s86
    s_lshl_b32 s76, s76, 1
    s_mul_i32 s76, s76, 114688
    s_lshl_b32 s11, s85, 1
    s_add_u32 s11, s11, s87
    s_lshl_b32 s12, s11, 11
    s_add_u32 s76, s76, s12
    s_add_u32 s76, s76, 0x600000
    s_add_u32 s78, s76, 114688
    s_lshl_b32 s12, s4, 1
    s_add_u32 s12, s12, s86
    s_mul_i32 s12, s12, 56
    s_add_u32 s11, s11, s12
    s_lshl_b32 s11, s11, 7
    v_mfma_f32_32x32x16_bf16 v[96:111], v[44:47], v[32:35], v[96:111]
    s_add_u32 s11, s11, 0xf40000
    v_mov_b32 v249, s11
    s_mov_b32 s60, s20
    s_mov_b32 s61, s21
    s_mov_b32 s62, 0x62000
    s_mov_b32 s63, 0x20000
    s_lshr_b32 s11, s10, 1
    s_xor_b32 s11, s11, s2
    s_and_b32 s11, s11, 1
    s_lshr_b32 s12, s2, 3
    s_mul_i32 s38, s11, 32
    s_add_u32 s38, s38, s12
    s_mul_i32 s13, s38, 147
    s_lshr_b32 s13, s13, 10
    s_mul_i32 s9, s13, 7
    v_mfma_f32_32x32x16_bf16 v[112:127], v[44:47], v[36:39], v[112:127]
    s_sub_u32 s9, s38, s9
    s_bfe_u32 s38, s2, 0x20001
    s_lshl_b32 s38, s38, 3
    s_add_u32 s8, s38, s13
    s_mul_i32 s11, s11, 8
    s_add_u32 s12, s12, s11
    s_cmp_lt_u32 s12, 32
    s_cselect_b32 s88, 1, 0
    s_mov_b32 s56, s28
    s_mov_b32 s57, s29
    s_mov_b32 s58, 0x188000
    s_mov_b32 s59, 0x20000
    v_lshrrev_b32 v16, 3, v251
    v_and_b32 v17, 7, v251
    v_bfe_u32 v18, v16, 1, 1
    v_mfma_f32_32x32x16_bf16 v[64:79], v[56:59], v[48:51], v[64:79]
    v_lshlrev_b32 v18, 2, v18
    v_xor_b32 v18, v18, v17
    v_lshlrev_b32 v18, 4, v18
    v_mul_u32_u24 v16, 896, v16
    s_lshl_b32 s11, s9, 7
    v_add3_u32 v226, v16, v18, s11
    s_and_b32 s12, s3, 3
    s_mul_i32 s22, s12, 401408
    s_add_u32 s77, s22, 401408
    s_lshl_b32 s84, s9, 2
    s_and_b32 s11, s8, 3
    s_add_u32 s84, s84, s11
    s_mul_i32 s11, s84, 14336
    s_add_u32 s0, s22, s11
    s_cmp_eq_u32 s88, 0
    s_cselect_b32 s0, 0x40000000, s0
    v_mfma_f32_32x32x16_bf16 v[80:95], v[56:59], v[52:55], v[80:95]
    s_mul_i32 s1, s12, 26624
    s_add_u32 s1, s1, 49152
    s_and_b32 s12, s3, 3
    s_mul_i32 s13, s12, 26624
    s_add_u32 s13, s13, 49152
    v_bfe_u32 v240, v251, 2, 2
    v_lshrrev_b32 v243, 5, v251
    v_lshl_add_u32 v243, v243, 2, v240
    v_lshl_add_u32 v243, v243, 7, s13
    v_lshrrev_b32 v240, 1, v240
    v_lshlrev_b32 v240, 6, v240
    v_bfe_u32 v244, v251, 4, 1
    v_add_u32 v244, s12, v244
    v_and_b32 v245, 3, v251
    v_lshlrev_b32 v245, 3, v245
    v_mfma_f32_32x32x16_bf16 v[96:111], v[60:63], v[48:51], v[96:111]
    v_add_u32 v246, 0, v244
    v_and_b32 v246, 3, v246
    v_lshl_add_u32 v246, v246, 5, v245
    v_xor_b32 v246, v246, v240
    v_add_u32 v227, v246, v243
    v_add_u32 v246, 2, v244
    v_and_b32 v246, 3, v246
    v_lshl_add_u32 v246, v246, 5, v245
    v_xor_b32 v246, v246, v240
    v_add_u32 v228, v246, v243
    s_lshl_b32 s11, s8, 2
    s_add_u32 s11, s11, s12
    s_mul_i32 s11, s11, 1792
    s_add_u32 s11, s11, 0xf40000
    v_min_u32 v240, 13, v251
    v_mfma_f32_32x32x16_bf16 v[112:127], v[60:63], v[52:55], v[112:127]
    v_lshl_add_u32 v248, v240, 7, s11
    s_mul_i32 s11, s8, 229376
    s_mul_i32 s13, s12, 28672
    s_add_u32 s11, s11, s13
    s_add_u32 s11, s11, 0x600000
    v_add_u32 v225, s11, v250
    s_lshl_b32 s73, s84, 10
    s_mul_i32 s23, s12, 100352
    v_add_u32 v229, 114688, v225
    s_nop 8
    v_mul_f32 v192, v64, v64
    v_mul_f32 v193, v65, v65
    v_mul_f32 v194, v66, v66
    v_mul_f32 v195, v67, v67
    v_mul_f32 v196, v68, v68
    v_mul_f32 v197, v69, v69
    v_mul_f32 v198, v70, v70
    v_mul_f32 v199, v71, v71
    v_fma_f32 v192, v192, s94, v235
    v_fma_f32 v193, v193, s94, v235
    v_fma_f32 v194, v194, s94, v235
    v_fma_f32 v195, v195, s94, v235
    v_fma_f32 v196, v196, s94, v235
    v_fma_f32 v197, v197, s94, v235
    v_fma_f32 v198, v198, s94, v235
    v_fma_f32 v199, v199, s94, v235
    v_mul_f32 v192, v192, v64
    v_mul_f32 v193, v193, v65
    v_mul_f32 v194, v194, v66
    v_mul_f32 v195, v195, v67
    v_mul_f32 v196, v196, v68
    v_mul_f32 v197, v197, v69
    v_mul_f32 v198, v198, v70
    v_mul_f32 v199, v199, v71
    v_exp_f32 v192, v192
    v_mul_f32 v72, v72, v64
    v_exp_f32 v193, v193
    v_mul_f32 v73, v73, v65
    v_exp_f32 v194, v194
    v_mul_f32 v74, v74, v66
    v_exp_f32 v195, v195
    v_mul_f32 v75, v75, v67
    v_exp_f32 v196, v196
    v_mul_f32 v76, v76, v68
    v_exp_f32 v197, v197
    v_mul_f32 v77, v77, v69
    v_exp_f32 v198, v198
    v_mul_f32 v78, v78, v70
    v_exp_f32 v199, v199
    v_mul_f32 v79, v79, v71
    v_fma_f32 v192, v192, v216, v216
    v_fma_f32 v193, v193, v216, v216
    v_fma_f32 v194, v194, v216, v216
    v_fma_f32 v195, v195, v216, v216
    v_fma_f32 v196, v196, v216, v216
    v_fma_f32 v197, v197, v216, v216
    v_fma_f32 v198, v198, v216, v216
    v_fma_f32 v199, v199, v216, v216
    v_rcp_f32 v192, v192
    v_rcp_f32 v193, v193
    v_rcp_f32 v194, v194
    v_mul_f32 v72, v72, v192
    v_rcp_f32 v195, v195
    v_mul_f32 v73, v73, v193
    v_rcp_f32 v196, v196
    v_mul_f32 v74, v74, v194
    v_rcp_f32 v197, v197
    v_mul_f32 v75, v75, v195
    v_rcp_f32 v198, v198
    v_mul_f32 v76, v76, v196
    v_rcp_f32 v199, v199
    v_mul_f32 v77, v77, v197
    v_mul_f32 v78, v78, v198
    v_mul_f32 v79, v79, v199
    v_cvt_pk_bf16_f32 v200, v72, v73
    v_cvt_pk_bf16_f32 v201, v74, v75
    v_cvt_pk_bf16_f32 v202, v76, v77
    v_cvt_pk_bf16_f32 v203, v78, v79
    buffer_store_dwordx4 v[200:203], v250, s[52:55], s76 offen offset:0 sc1
    v_mul_f32 v192, v80, v80
    v_mul_f32 v193, v81, v81
    v_mul_f32 v194, v82, v82
    v_mul_f32 v195, v83, v83
    v_mul_f32 v196, v84, v84
    v_mul_f32 v197, v85, v85
    v_mul_f32 v198, v86, v86
    v_mul_f32 v199, v87, v87
    v_fma_f32 v192, v192, s94, v235
    v_fma_f32 v193, v193, s94, v235
    v_fma_f32 v194, v194, s94, v235
    v_fma_f32 v195, v195, s94, v235
    v_fma_f32 v196, v196, s94, v235
    v_fma_f32 v197, v197, s94, v235
    v_fma_f32 v198, v198, s94, v235
    v_fma_f32 v199, v199, s94, v235
    v_mul_f32 v192, v192, v80
    v_mul_f32 v193, v193, v81
    v_mul_f32 v194, v194, v82
    v_mul_f32 v195, v195, v83
    v_mul_f32 v196, v196, v84
    v_mul_f32 v197, v197, v85
    v_mul_f32 v198, v198, v86
    v_mul_f32 v199, v199, v87
    v_exp_f32 v192, v192
    v_mul_f32 v88, v88, v80
    v_exp_f32 v193, v193
    v_mul_f32 v89, v89, v81
    v_exp_f32 v194, v194
    v_mul_f32 v90, v90, v82
    v_exp_f32 v195, v195
    v_mul_f32 v91, v91, v83
    v_exp_f32 v196, v196
    v_mul_f32 v92, v92, v84
    v_exp_f32 v197, v197
    v_mul_f32 v93, v93, v85
    v_exp_f32 v198, v198
    v_mul_f32 v94, v94, v86
    v_exp_f32 v199, v199
    v_mul_f32 v95, v95, v87
    v_fma_f32 v192, v192, v218, v218
    v_fma_f32 v193, v193, v218, v218
    v_fma_f32 v194, v194, v218, v218
    v_fma_f32 v195, v195, v218, v218
    v_fma_f32 v196, v196, v218, v218
    v_fma_f32 v197, v197, v218, v218
    v_fma_f32 v198, v198, v218, v218
    v_fma_f32 v199, v199, v218, v218
    v_rcp_f32 v192, v192
    v_rcp_f32 v193, v193
    v_rcp_f32 v194, v194
    v_mul_f32 v88, v88, v192
    v_rcp_f32 v195, v195
    v_mul_f32 v89, v89, v193
    v_rcp_f32 v196, v196
    v_mul_f32 v90, v90, v194
    v_rcp_f32 v197, v197
    v_mul_f32 v91, v91, v195
    v_rcp_f32 v198, v198
    v_mul_f32 v92, v92, v196
    v_rcp_f32 v199, v199
    v_mul_f32 v93, v93, v197
    v_mul_f32 v94, v94, v198
    v_mul_f32 v95, v95, v199
    v_cvt_pk_bf16_f32 v204, v88, v89
    v_cvt_pk_bf16_f32 v205, v90, v91
    v_cvt_pk_bf16_f32 v206, v92, v93
    v_cvt_pk_bf16_f32 v207, v94, v95
    buffer_store_dwordx4 v[204:207], v250, s[52:55], s78 offen offset:0 sc1
    v_mul_f32 v192, v96, v96
    v_mul_f32 v193, v97, v97
    v_mul_f32 v194, v98, v98
    v_mul_f32 v195, v99, v99
    v_mul_f32 v196, v100, v100
    v_mul_f32 v197, v101, v101
    v_mul_f32 v198, v102, v102
    v_mul_f32 v199, v103, v103
    v_fma_f32 v192, v192, s94, v235
    v_fma_f32 v193, v193, s94, v235
    v_fma_f32 v194, v194, s94, v235
    v_fma_f32 v195, v195, s94, v235
    v_fma_f32 v196, v196, s94, v235
    v_fma_f32 v197, v197, s94, v235
    v_fma_f32 v198, v198, s94, v235
    v_fma_f32 v199, v199, s94, v235
    v_mul_f32 v192, v192, v96
    v_mul_f32 v193, v193, v97
    v_mul_f32 v194, v194, v98
    v_mul_f32 v195, v195, v99
    v_mul_f32 v196, v196, v100
    v_mul_f32 v197, v197, v101
    v_mul_f32 v198, v198, v102
    v_mul_f32 v199, v199, v103
    v_exp_f32 v192, v192
    v_mul_f32 v104, v104, v96
    v_exp_f32 v193, v193
    v_mul_f32 v105, v105, v97
    v_exp_f32 v194, v194
    v_mul_f32 v106, v106, v98
    v_exp_f32 v195, v195
    v_mul_f32 v107, v107, v99
    v_exp_f32 v196, v196
    v_mul_f32 v108, v108, v100
    v_exp_f32 v197, v197
    v_mul_f32 v109, v109, v101
    v_exp_f32 v198, v198
    v_mul_f32 v110, v110, v102
    v_exp_f32 v199, v199
    v_mul_f32 v111, v111, v103
    v_fma_f32 v192, v192, v216, v216
    v_fma_f32 v193, v193, v216, v216
    v_fma_f32 v194, v194, v216, v216
    v_fma_f32 v195, v195, v216, v216
    v_fma_f32 v196, v196, v216, v216
    v_fma_f32 v197, v197, v216, v216
    v_fma_f32 v198, v198, v216, v216
    v_fma_f32 v199, v199, v216, v216
    v_rcp_f32 v192, v192
    v_rcp_f32 v193, v193
    v_rcp_f32 v194, v194
    v_mul_f32 v104, v104, v192
    v_rcp_f32 v195, v195
    v_mul_f32 v105, v105, v193
    v_rcp_f32 v196, v196
    v_mul_f32 v106, v106, v194
    v_rcp_f32 v197, v197
    v_mul_f32 v107, v107, v195
    v_rcp_f32 v198, v198
    v_mul_f32 v108, v108, v196
    v_rcp_f32 v199, v199
    v_mul_f32 v109, v109, v197
    v_mul_f32 v110, v110, v198
    v_mul_f32 v111, v111, v199
    v_cvt_pk_bf16_f32 v208, v104, v105
    v_cvt_pk_bf16_f32 v209, v106, v107
    v_cvt_pk_bf16_f32 v210, v108, v109
    v_cvt_pk_bf16_f32 v211, v110, v111
    buffer_store_dwordx4 v[208:211], v250, s[52:55], s76 offen offset:1024 sc1
    v_mul_f32 v192, v112, v112
    v_mul_f32 v193, v113, v113
    v_mul_f32 v194, v114, v114
    v_mul_f32 v195, v115, v115
    v_mul_f32 v196, v116, v116
    v_mul_f32 v197, v117, v117
    v_mul_f32 v198, v118, v118
    v_mul_f32 v199, v119, v119
    v_fma_f32 v192, v192, s94, v235
    v_fma_f32 v193, v193, s94, v235
    v_fma_f32 v194, v194, s94, v235
    v_fma_f32 v195, v195, s94, v235
    v_fma_f32 v196, v196, s94, v235
    v_fma_f32 v197, v197, s94, v235
    v_fma_f32 v198, v198, s94, v235
    v_fma_f32 v199, v199, s94, v235
    v_mul_f32 v192, v192, v112
    v_mul_f32 v193, v193, v113
    v_mul_f32 v194, v194, v114
    v_mul_f32 v195, v195, v115
    v_mul_f32 v196, v196, v116
    v_mul_f32 v197, v197, v117
    v_mul_f32 v198, v198, v118
    v_mul_f32 v199, v199, v119
    v_exp_f32 v192, v192
    v_mul_f32 v120, v120, v112
    v_exp_f32 v193, v193
    v_mul_f32 v121, v121, v113
    v_exp_f32 v194, v194
    v_mul_f32 v122, v122, v114
    v_exp_f32 v195, v195
    v_mul_f32 v123, v123, v115
    v_exp_f32 v196, v196
    v_mul_f32 v124, v124, v116
    v_exp_f32 v197, v197
    v_mul_f32 v125, v125, v117
    v_exp_f32 v198, v198
    v_mul_f32 v126, v126, v118
    v_exp_f32 v199, v199
    v_mul_f32 v127, v127, v119
    v_fma_f32 v192, v192, v218, v218
    v_fma_f32 v193, v193, v218, v218
    v_fma_f32 v194, v194, v218, v218
    v_fma_f32 v195, v195, v218, v218
    v_fma_f32 v196, v196, v218, v218
    v_fma_f32 v197, v197, v218, v218
    v_fma_f32 v198, v198, v218, v218
    v_fma_f32 v199, v199, v218, v218
    v_rcp_f32 v192, v192
    v_rcp_f32 v193, v193
    v_rcp_f32 v194, v194
    v_mul_f32 v120, v120, v192
    v_rcp_f32 v195, v195
    v_mul_f32 v121, v121, v193
    v_rcp_f32 v196, v196
    v_mul_f32 v122, v122, v194
    v_rcp_f32 v197, v197
    v_mul_f32 v123, v123, v195
    v_rcp_f32 v198, v198
    v_mul_f32 v124, v124, v196
    v_rcp_f32 v199, v199
    v_mul_f32 v125, v125, v197
    v_mul_f32 v126, v126, v198
    v_mul_f32 v127, v127, v199
    v_cvt_pk_bf16_f32 v212, v120, v121
    v_cvt_pk_bf16_f32 v213, v122, v123
    v_cvt_pk_bf16_f32 v214, v124, v125
    v_cvt_pk_bf16_f32 v215, v126, v127
    buffer_store_dwordx4 v[212:215], v250, s[52:55], s78 offen offset:1024 sc1
    s_setprio 0
    s_waitcnt vmcnt(0)
    s_mov_b64 exec, 1
    buffer_store_dword v242, v249, s[52:55], 0 offen sc1
    s_mov_b64 exec, -1
    s_cmp_eq_u32 s88, 0
    s_cbranch_scc1 Lexit
    s_add_u32 m0, s1, 0
    s_nop 0
    buffer_load_dwordx4 v226, s[56:59], s0 offen lds
    s_add_u32 s0, s0, 7168
    s_add_u32 m0, s1, 1024
    s_nop 0
    buffer_load_dwordx4 v226, s[56:59], s0 offen lds
    s_add_u32 s0, s0, 7168
    s_cmp_eq_u32 s0, s77
    s_cselect_b32 s0, s22, s0
    s_add_u32 m0, s1, 2048
    s_nop 0
    buffer_load_dwordx4 v226, s[56:59], s0 offen lds
    s_add_u32 s0, s0, 7168
    s_add_u32 m0, s1, 3072
    s_nop 0
    buffer_load_dwordx4 v226, s[56:59], s0 offen lds
    s_add_u32 s0, s0, 7168
    s_cmp_eq_u32 s0, s77
    s_cselect_b32 s0, s22, s0
    s_add_u32 m0, s1, 4096
    s_nop 0
    buffer_load_dwordx4 v226, s[56:59], s0 offen lds
    s_add_u32 s0, s0, 7168
    s_add_u32 m0, s1, 5120
    s_nop 0
    buffer_load_dwordx4 v226, s[56:59], s0 offen lds
    s_add_u32 s0, s0, 7168
    s_cmp_eq_u32 s0, s77
    s_cselect_b32 s0, s22, s0
    s_add_u32 m0, s1, 6144
    s_nop 0
    buffer_load_dwordx4 v226, s[56:59], s0 offen lds
    s_add_u32 s0, s0, 7168
    s_add_u32 m0, s1, 7168
    s_nop 0
    buffer_load_dwordx4 v226, s[56:59], s0 offen lds
    s_add_u32 s0, s0, 7168
    s_cmp_eq_u32 s0, s77
    s_cselect_b32 s0, s22, s0
    s_add_u32 m0, s1, 8192
    s_nop 0
    buffer_load_dwordx4 v226, s[56:59], s0 offen lds
    s_add_u32 s0, s0, 7168
    s_add_u32 m0, s1, 9216
    s_nop 0
    buffer_load_dwordx4 v226, s[56:59], s0 offen lds
    s_add_u32 s0, s0, 7168
    s_cmp_eq_u32 s0, s77
    s_cselect_b32 s0, s22, s0
    s_add_u32 m0, s1, 10240
    s_nop 0
    buffer_load_dwordx4 v226, s[56:59], s0 offen lds
    s_add_u32 s0, s0, 7168
    s_add_u32 m0, s1, 11264
    s_nop 0
    buffer_load_dwordx4 v226, s[56:59], s0 offen lds
    s_add_u32 s0, s0, 7168
    s_cmp_eq_u32 s0, s77
    s_cselect_b32 s0, s22, s0
    s_add_u32 m0, s1, 12288
    s_nop 0
    buffer_load_dwordx4 v226, s[56:59], s0 offen lds
    s_add_u32 s0, s0, 7168
    s_add_u32 m0, s1, 13312
    s_nop 0
    buffer_load_dwordx4 v226, s[56:59], s0 offen lds
    s_add_u32 s0, s0, 7168
    s_cmp_eq_u32 s0, s77
    s_cselect_b32 s0, s22, s0
    s_add_u32 m0, s1, 14336
    s_nop 0
    buffer_load_dwordx4 v226, s[56:59], s0 offen lds
    s_add_u32 s0, s0, 7168
    s_add_u32 m0, s1, 15360
    s_nop 0
    buffer_load_dwordx4 v226, s[56:59], s0 offen lds
    s_add_u32 s0, s0, 7168
    s_cmp_eq_u32 s0, s77
    s_cselect_b32 s0, s22, s0
    s_add_u32 m0, s1, 16384
    s_nop 0
    buffer_load_dwordx4 v226, s[56:59], s0 offen lds
    s_add_u32 s0, s0, 7168
    s_add_u32 m0, s1, 17408
    s_nop 0
    buffer_load_dwordx4 v226, s[56:59], s0 offen lds
    s_add_u32 s0, s0, 7168
    s_cmp_eq_u32 s0, s77
    s_cselect_b32 s0, s22, s0
    s_add_u32 m0, s1, 18432
    s_nop 0
    buffer_load_dwordx4 v226, s[56:59], s0 offen lds
    s_add_u32 s0, s0, 7168
    s_add_u32 m0, s1, 19456
    s_nop 0
    buffer_load_dwordx4 v226, s[56:59], s0 offen lds
    s_add_u32 s0, s0, 7168
    s_cmp_eq_u32 s0, s77
    s_cselect_b32 s0, s22, s0
    s_add_u32 m0, s1, 20480
    s_nop 0
    buffer_load_dwordx4 v226, s[56:59], s0 offen lds
    s_add_u32 s0, s0, 7168
    s_add_u32 m0, s1, 21504
    s_nop 0
    buffer_load_dwordx4 v226, s[56:59], s0 offen lds
    s_add_u32 s0, s0, 7168
    s_cmp_eq_u32 s0, s77
    s_cselect_b32 s0, s22, s0
    s_add_u32 m0, s1, 22528
    s_nop 0
    buffer_load_dwordx4 v226, s[56:59], s0 offen lds
    s_add_u32 s0, s0, 7168
    s_add_u32 m0, s1, 23552
    s_nop 0
    buffer_load_dwordx4 v226, s[56:59], s0 offen lds
    s_add_u32 s0, s0, 7168
    s_cmp_eq_u32 s0, s77
    s_cselect_b32 s0, s22, s0
    s_add_u32 m0, s1, 24576
    s_nop 0
    buffer_load_dwordx4 v226, s[56:59], s0 offen lds
    s_add_u32 s0, s0, 7168
    s_add_u32 m0, s1, 25600
    s_nop 0
    buffer_load_dwordx4 v226, s[56:59], s0 offen lds
    s_add_u32 s0, s0, 7168
    s_cmp_eq_u32 s0, s77
    s_cselect_b32 s0, s22, s0
    s_branch Ldown
Lsetup_lo:
    s_lshl_b32 s15, s12, 10
    v_bfe_u32 v25, v16, 1, 1
    v_lshlrev_b32 v25, 2, v25
    v_xor_b32 v25, v25, v17
    v_lshlrev_b32 v25, 4, v25
    s_lshl_b32 s38, s12, 3
    v_add_u32 v26, s38, v16
    s_and_b32 s86, s3, 1
    s_bfe_u32 s87, s3, 0x10001
    s_lshl_b32 s11, s5, 1
    s_add_u32 s38, s5, 12
    s_cmp_eq_u32 s39, 1
    s_cselect_b32 s85, s38, s11
    v_mul_u32_u24 v27, 3584, v26
    s_lshl_b32 s11, s85, 7
    v_add3_u32 v236, v27, v25, s11
    v_xor_b32 v237, 32, v236
    v_lshlrev_b32 v35, 1, v0
    s_waitcnt lgkmcnt(0)
    s_mov_b32 s68, s30
    s_mov_b32 s69, s31
    s_mov_b32 s70, 0x380
    s_mov_b32 s71, 0x20000
    buffer_load_ushort v30, v35, s[68:71], 0 offen
    buffer_load_ushort v32, v35, s[68:71], 0 offen offset:512
    s_getpc_b64 s[0:1]
Lpc:
    s_sub_u32 s0, s0, Lpc-gated_mix__mha_block__glu_gated_geglu__prompt_kernel
    s_subb_u32 s1, s1, 0
    s_lshr_b32 s11, s2, 3
    s_lshl_b32 s11, s11, 2
    s_add_u32 s11, s11, s3
    s_lshl_b32 s11, s11, 9
    v_and_b32 v35, 3, v251
    v_lshl_add_u32 v35, v35, 7, s11
    v_min_u32 v35, Lend-gated_mix__mha_block__glu_gated_geglu__prompt_kernel, v35
    global_load_dword v238, v35, s[0:1]
    s_mov_b32 s52, s36
    s_mov_b32 s53, s37
    s_mov_b32 s54, 0x1000000
    s_mov_b32 s55, 0x20000
    s_and_b32 s11, s2, 7
    s_lshr_b32 s12, s2, 3
    s_lshl_b32 s13, s11, 1
    s_lshr_b32 s38, s12, 4
    s_add_u32 s6, s13, s38
    s_and_b32 s7, s12, 15
    s_mov_b32 s98, 0xffff0000
    s_mov_b32 s99, 0xffff0000
    v_bfe_u32 v18, v251, 2, 2
    v_and_b32 v19, 3, v251
    v_lshlrev_b32 v19, 3, v19
    v_lshrrev_b32 v20, 5, v251
    v_and_b32 v21, 31, v251
    v_lshl_add_u32 v22, v20, 3, v18
    v_lshlrev_b32 v22, 7, v22
    v_lshrrev_b32 v23, 1, v18
    v_lshlrev_b32 v23, 6, v23
    v_bfe_u32 v24, v21, 1, 3
    v_xor_b32 v24, v24, v20
    v_lshlrev_b32 v24, 4, v24
    s_lshl_b32 s11, s86, 13
    v_lshl_add_u32 v7, v21, 7, v24
    v_add_u32 v7, s11, v7
    s_lshl_b32 s81, s82, 14
    s_mov_b32 s90, 0
    s_mov_b32 s91, -1
    s_mov_b32 s94, 0x88880000
    s_mov_b32 s95, 0x88880000
    v_lshl_add_u32 v10, v20, 2, v18
    v_lshlrev_b32 v10, 3, v10
    v_bfe_u32 v27, v0, 4, 1
    v_lshlrev_b32 v34, 11, v27
    v_bfe_u32 v27, v0, 2, 1
    v_lshl_add_u32 v34, v27, 9, v34
    v_bfe_u32 v27, v0, 5, 3
    v_lshl_add_u32 v34, v27, 6, v34
    v_bfe_u32 v27, v0, 3, 1
    v_lshl_add_u32 v34, v27, 5, v34
    v_and_b32 v27, 3, v0
    v_lshl_add_u32 v34, v27, 3, v34
    v_add_u32 v34, 159744, v34
    v_mov_b32 v31, 0
    v_mov_b32 v33, 0
    s_lshr_b32 s11, s82, 2
    s_lshl_b32 s11, s11, 10
    s_and_b32 s12, s82, 3
    s_lshl_b32 s12, s12, 7
    s_add_u32 s11, s11, s12
    s_add_u32 s84, s11, 159744
    s_mul_i32 s11, s87, 56
    s_add_u32 s12, s11, 32
    v_mov_b32 v27, s11
    v_mov_b32 v28, s12
    v_cndmask_b32 v27, v27, v28, s[98:99]
    v_add_u32 v27, v27, v19
    v_xor_b32 v27, v27, v23
    v_add_u32 v1, v27, v22
    v_lshlrev_b32 v24, 6, v18
    s_mul_i32 s11, s87, 112
    s_add_u32 s12, s11, 32
    s_cmp_eq_u32 s5, 15
    s_cselect_b32 s11, s12, s11
    v_bfe_u32 v27, v251, 4, 1
    v_lshl_add_u32 v27, v27, 5, v19
    v_add_u32 v27, s11, v27
    v_lshl_add_u32 v28, v22, 1, 0
    v_add_u32 v28, 4096, v28
    v_xor_b32 v29, v27, v24
    v_add_u32 v2, v29, v28
    v_add_u32 v27, 56, v27
    v_xor_b32 v29, v27, v24
    v_add_u32 v3, v29, v28
    s_cmp_eq_u32 s39, 1
    s_mov_b32 s11, 0x84084084
    s_cselect_b32 s92, s11, 0x43210a98
    s_mov_b32 s11, 0x840840
    s_cselect_b32 s93, s11, 0xa98765
    v_mov_b32 v56, 0
    v_mov_b32 v57, 0
    v_mov_b32 v58, 0
    v_mov_b32 v59, 0
    v_mov_b32 v60, 0
    v_mov_b32 v61, 0
    v_mov_b32 v62, 0
    v_mov_b32 v63, 0
    v_mov_b32 v64, 0
    v_mov_b32 v65, 0
    v_mov_b32 v66, 0
    v_mov_b32 v67, 0
    v_mov_b32 v68, 0
    v_mov_b32 v69, 0
    v_mov_b32 v70, 0
    v_mov_b32 v71, 0
    v_mov_b32 v72, 0
    v_mov_b32 v73, 0
    v_mov_b32 v74, 0
    v_mov_b32 v75, 0
    v_mov_b32 v76, 0
    v_mov_b32 v77, 0
    v_mov_b32 v78, 0
    v_mov_b32 v79, 0
    v_mov_b32 v80, 0
    v_mov_b32 v81, 0
    v_mov_b32 v82, 0
    v_mov_b32 v83, 0
    v_mov_b32 v84, 0
    v_mov_b32 v85, 0
    v_mov_b32 v86, 0
    v_mov_b32 v87, 0
    v_mov_b32 v88, 0
    v_mov_b32 v89, 0
    v_mov_b32 v90, 0
    v_mov_b32 v91, 0
    v_mov_b32 v92, 0
    v_mov_b32 v93, 0
    v_mov_b32 v94, 0
    v_mov_b32 v95, 0
    v_mov_b32 v96, 0
    v_mov_b32 v97, 0
    v_mov_b32 v98, 0
    v_mov_b32 v99, 0
    v_mov_b32 v100, 0
    v_mov_b32 v101, 0
    v_mov_b32 v102, 0
    v_mov_b32 v103, 0
    v_mov_b32 v104, 0
    v_mov_b32 v105, 0
    v_mov_b32 v106, 0
    v_mov_b32 v107, 0
    v_mov_b32 v108, 0
    v_mov_b32 v109, 0
    v_mov_b32 v110, 0
    v_mov_b32 v111, 0
    v_mov_b32 v112, 0
    v_mov_b32 v113, 0
    v_mov_b32 v114, 0
    v_mov_b32 v115, 0
    v_mov_b32 v116, 0
    v_mov_b32 v117, 0
    v_mov_b32 v118, 0
    v_mov_b32 v119, 0
    v_mov_b32 v120, 0
    v_mov_b32 v121, 0
    v_mov_b32 v122, 0
    v_mov_b32 v123, 0
    v_mov_b32 v124, 0
    v_mov_b32 v125, 0
    v_mov_b32 v126, 0
    v_mov_b32 v127, 0
    s_mov_b32 s72, 0
    s_lshl_b32 s22, s5, 1
    s_add_u32 s22, s22, s87
    s_lshl_b32 s77, s4, 1
    s_add_u32 s77, s77, s86
    s_lshl_b32 s77, s77, 1
    s_and_b32 s11, s22, 15
    s_lshl_b32 s11, s11, 6
    s_add_u32 s12, s77, s11
    s_cmp_lt_u32 s22, 16
    s_cselect_b32 s96, 0x3e8b97f6, 1.0
    s_cselect_b32 s23, 0xffff, 0
    s_cselect_b32 s13, 0, 12
    s_cselect_b32 s14, 11, 12
    s_cselect_b32 s11, 0x400000, 0
    s_lshl_b32 s12, s12, s14
    s_add_u32 s0, s11, s12
    s_lshl_b32 s12, 1, s14
    s_add_u32 s1, s0, s12
    v_lshrrev_b32 v27, 1, v251
    v_xor_b32 v27, v27, v251
    v_bfe_u32 v27, v27, 2, 1
    v_mul_u32_u24 v27, s13, v27
    v_xor_b32 v27, v27, v251
    v_lshlrev_b32 v233, 4, v27
    s_lshl_b32 s11, s2, 1
    s_add_u32 s11, s11, s86
    s_lshl_b32 s11, s11, 8
    s_add_u32 s11, s11, 0xf80000
    v_lshl_add_u32 v232, v251, 2, s11
    s_lshl_b32 s12, s4, 1
    s_add_u32 s12, s12, s86
    s_lshl_b32 s12, s12, 7
    s_add_u32 s12, s12, 0xf00000
    s_lshl_b32 s13, s5, 1
    s_add_u32 s13, s13, s87
    s_lshl_b32 s13, s13, 1
    s_sub_u32 s38, s13, 48
    s_add_u32 s13, s38, 31
    v_add_u32 v27, s13, v251
    v_mov_b32 v28, s22
    v_cmp_eq_u32 vcc, 0, v251
    s_nop 1
    v_cndmask_b32 v27, v27, v28, vcc
    v_lshl_add_u32 v241, v27, 12, s12
    s_waitcnt vmcnt(1)
    ds_write_b64 v34, v[30:31]
    ds_write_b64 v34, v[32:33] offset:1024
    s_mov_b32 s68, s34
    s_mov_b32 s69, s35
    s_mov_b32 s70, 0x100
    s_mov_b32 s71, 0x20000
    s_cmp_eq_u32 s39, 1
    s_cbranch_scc1 Lpa_s_entry
    s_and_b32 s12, s92, 15
    s_lshl_b32 s12, s12, 12
    s_add_u32 s12, s12, 114688
    s_lshr_b64 s[92:93], s[92:93], 4
    v_add_u32 v4, s12, v1
    v_add_u32 v11, s84, v10
    v_cndmask_b32 v4, v4, v11, s[94:95]
    s_or_b32 s11, s81, 0
    v_xor_b32 v8, s11, v7
    v_xor_b32 v9, 32, v8
    s_waitcnt lgkmcnt(0)
    s_barrier
.p2align 5
Lpa_r:
    v_mfma_f32_32x32x16_bf16 v[96:111], v[64:67], v[56:59], v[96:111]
    ds_read_b128 v[16:19], v8 offset:0
    ds_read_b128 v[20:23], v8 offset:4096
    ds_read_b64_tr_b16 v[24:25], v4 offset:0
    v_mfma_f32_32x32x16_bf16 v[112:127], v[64:67], v[60:63], v[112:127]
    ds_read_b64_tr_b16 v[26:27], v4 offset:512
    ds_read_b128 v[28:31], v9 offset:0
    ds_read_b128 v[32:35], v9 offset:4096
    v_mfma_f32_32x32x16_bf16 v[96:111], v[76:79], v[68:71], v[96:111]
    ds_read_b64_tr_b16 v[36:37], v4 offset:2048
    ds_read_b64_tr_b16 v[38:39], v4 offset:2560
    s_add_u32 s84, s84, 64
    s_and_b32 s12, s92, 15
    s_lshl_b32 s12, s12, 12
    s_add_u32 s12, s12, 114688
    s_lshr_b64 s[92:93], s[92:93], 4
    v_add_u32 v4, s12, v1
    v_add_u32 v11, s84, v10
    v_cndmask_b32 v4, v4, v11, s[94:95]
    s_or_b32 s11, s81, 64
    v_xor_b32 v8, s11, v7
    v_xor_b32 v9, 32, v8
    v_mfma_f32_32x32x16_bf16 v[112:127], v[76:79], v[72:75], v[112:127]
    s_waitcnt lgkmcnt(0)
    v_mfma_f32_32x32x16_bf16 v[96:111], v[24:27], v[16:19], v[96:111]
    ds_read_b128 v[56:59], v8 offset:0
    ds_read_b128 v[60:63], v8 offset:4096
    ds_read_b64_tr_b16 v[64:65], v4 offset:0
    v_mfma_f32_32x32x16_bf16 v[112:127], v[24:27], v[20:23], v[112:127]
    ds_read_b64_tr_b16 v[66:67], v4 offset:512
    ds_read_b128 v[68:71], v9 offset:0
    ds_read_b128 v[72:75], v9 offset:4096
    v_mfma_f32_32x32x16_bf16 v[96:111], v[36:39], v[28:31], v[96:111]
    ds_read_b64_tr_b16 v[76:77], v4 offset:2048
    ds_read_b64_tr_b16 v[78:79], v4 offset:2560
    s_add_u32 s84, s84, 64
    s_cmp_eq_u32 s84, 160256
    s_cselect_b32 s84, 160768, s84
    s_cmp_eq_u32 s84, 161152
    s_cselect_b32 s84, 159744, s84
    s_add_u32 s81, s81, 16384
    s_cmp_eq_u32 s81, 114688
    s_cselect_b32 s81, 0, s81
    s_and_b32 s12, s92, 15
    s_lshl_b32 s12, s12, 12
    s_add_u32 s12, s12, 114688
    s_lshr_b64 s[92:93], s[92:93], 4
    v_add_u32 v4, s12, v1
    v_add_u32 v11, s84, v10
    v_cndmask_b32 v4, v4, v11, s[94:95]
    s_or_b32 s11, s81, 0
    v_xor_b32 v8, s11, v7
    v_xor_b32 v9, 32, v8
    s_add_u32 s72, s72, 1
    s_cmp_lg_u32 s72, 4
    s_cbranch_scc1 Lpa_r_n
    buffer_load_dword v240, v252, s[68:71], 0 offen sc1
Lpa_r_n:
    s_cmp_lt_u32 s72, 7
    v_mfma_f32_32x32x16_bf16 v[112:127], v[36:39], v[32:35], v[112:127]
    s_waitcnt lgkmcnt(0)
    s_barrier
    s_cbranch_scc1 Lpa_r
    v_mfma_f32_32x32x16_bf16 v[96:111], v[64:67], v[56:59], v[96:111]
    v_mfma_f32_32x32x16_bf16 v[112:127], v[64:67], v[60:63], v[112:127]
    v_mfma_f32_32x32x16_bf16 v[96:111], v[76:79], v[68:71], v[96:111]
    v_mfma_f32_32x32x16_bf16 v[112:127], v[76:79], v[72:75], v[112:127]
    s_nop 10
    v_mov_b32 v16, v108
    v_mov_b32 v17, v124
    v_mul_f32 v96, s96, v96
    v_mul_f32 v97, s96, v97
    v_mul_f32 v98, s96, v98
    v_mul_f32 v99, s96, v99
    v_mul_f32 v100, s96, v100
    v_mul_f32 v101, s96, v101
    v_permlane32_swap_b32 v16, v17
    v_mul_f32 v102, s96, v102
    v_mul_f32 v103, s96, v103
    v_cvt_pk_bf16_f32 v76, v96, v97
    v_cvt_pk_bf16_f32 v77, v98, v99
    v_cvt_pk_bf16_f32 v17, v17, v17
    v_cvt_pk_bf16_f32 v78, v100, v101
    v_and_b32 v17, 0xffff0000, v17
    v_cvt_pk_bf16_f32 v79, v102, v103
    v_mul_f32 v17, 0xbfb8aa3b, v17
    buffer_store_dwordx4 v[76:79], v233, s[52:55], s0 offen sc1
    v_exp_f32 v17, v17
    v_mul_f32 v112, s96, v112
    v_mul_f32 v113, s96, v113
    v_add_f32 v17, 1.0, v17
    v_mul_f32 v114, s96, v114
    v_mul_f32 v115, s96, v115
    v_rcp_f32 v17, v17
    s_barrier
    v_mul_f32 v116, s96, v116
    v_mul_f32 v117, s96, v117
    v_cvt_pk_bf16_f32 v18, v17, v17
    v_mul_f32 v118, s96, v118
    v_mul_f32 v119, s96, v119
    v_and_b32 v17, 0xffff0000, v18
    v_cvt_pk_bf16_f32 v84, v112, v113
    v_and_b32 v18, s23, v18
    v_cvt_pk_bf16_f32 v85, v114, v115
    v_sub_f32 v17, 1.0, v17
    v_cvt_pk_bf16_f32 v86, v116, v117
    v_mov_b32 v19, v18
    v_cvt_pk_bf16_f32 v87, v118, v119
    v_cvt_pk_bf16_f32 v17, v17, v17
    buffer_store_dwordx4 v[84:87], v233, s[52:55], s1 offen sc1
    v_and_b32 v17, 0xffff0000, v17
    v_mul_f32 v104, s96, v104
    v_mul_f32 v105, s96, v105
    v_permlane32_swap_b32 v18, v19
    v_mul_f32 v106, s96, v106
    v_mul_f32 v107, s96, v107
    v_rcp_f32 v20, v17
    v_mul_f32 v108, s96, v108
    v_mul_f32 v109, s96, v109
    v_min_f32 v20, 0x7f000000, v20
    v_mul_f32 v110, s96, v110
    s_barrier
    v_mul_f32 v111, s96, v111
    buffer_store_dword v20, v232, s[52:55], 0 offen sc1
    v_cvt_pk_bf16_f32 v80, v104, v105
    v_cvt_pk_bf16_f32 v81, v106, v107
    v_cvt_pk_bf16_f32 v82, v108, v109
    v_cvt_pk_bf16_f32 v83, v110, v111
    v_cndmask_b32 v83, v83, v252, s[90:91]
    v_mul_f32 v120, s96, v120
    v_mul_f32 v121, s96, v121
    v_mul_f32 v122, s96, v122
    v_mul_f32 v123, s96, v123
    v_mul_f32 v124, s96, v124
    v_mul_f32 v125, s96, v125
    v_mul_f32 v126, s96, v126
    v_mul_f32 v127, s96, v127
    v_cvt_pk_bf16_f32 v88, v120, v121
    v_cvt_pk_bf16_f32 v89, v122, v123
    v_cvt_pk_bf16_f32 v90, v124, v125
    v_cvt_pk_bf16_f32 v91, v126, v127
    v_cndmask_b32 v91, v91, v252, s[90:91]
    v_cndmask_b32 v82, v82, v18, s[90:91]
    buffer_store_dwordx4 v[80:83], v233, s[52:55], s0 offen offset:1024 sc1
    v_cndmask_b32 v90, v90, v19, s[90:91]
    buffer_store_dwordx4 v[88:91], v233, s[52:55], s1 offen offset:1024 sc1
    s_barrier
    v_and_b32 v16, 3, v251
    s_lshl_b32 s11, s3, 2
    v_add_u32 v16, s11, v16
    v_bfe_u32 v17, v251, 3, 1
    v_lshl_add_u32 v16, v17, 4, v16
    v_bfe_u32 v17, v251, 2, 1
    v_lshlrev_b32 v17, 4, v17
    s_add_u32 s12, s6, 16
    v_add_u32 v17, s12, v17
    v_lshl_add_u32 v16, v17, 5, v16
    s_lshl_b32 s11, s6, 5
    s_lshl_b32 s12, s7, 1
    s_add_u32 s11, s11, s12
    v_and_b32 v17, 1, v251
    v_add_u32 v17, s11, v17
    v_cmp_gt_u32 vcc, 16, v251
    s_mov_b32 s11, 0xf00000
    s_nop 0
    v_cndmask_b32 v16, v17, v16, vcc
    v_lshl_add_u32 v243, v16, 7, s11
    v_mov_b32 v32, 0
    v_mov_b32 v33, 0
    v_mov_b32 v34, 0
    v_mov_b32 v35, 0
    v_mov_b32 v36, 0
    v_mov_b32 v37, 0
    v_mov_b32 v38, 0
    v_mov_b32 v39, 0
    v_mov_b32 v40, 0
    v_mov_b32 v41, 0
    v_mov_b32 v42, 0
    v_mov_b32 v43, 0
    v_mov_b32 v44, 0
    v_mov_b32 v45, 0
    v_mov_b32 v46, 0
    v_mov_b32 v47, 0
    v_mov_b32 v48, 0
    v_mov_b32 v49, 0
    v_mov_b32 v50, 0
    v_mov_b32 v51, 0
    v_mov_b32 v52, 0
    v_mov_b32 v53, 0
    v_mov_b32 v54, 0
    v_mov_b32 v55, 0
    v_mov_b32 v56, 0
    v_mov_b32 v57, 0
    v_mov_b32 v58, 0
    v_mov_b32 v59, 0
    v_mov_b32 v60, 0
    v_mov_b32 v61, 0
    v_mov_b32 v62, 0
    v_mov_b32 v63, 0
    v_mov_b32 v64, 0
    v_mov_b32 v65, 0
    v_mov_b32 v66, 0
    v_mov_b32 v67, 0
    v_mov_b32 v68, 0
    v_mov_b32 v69, 0
    v_mov_b32 v70, 0
    v_mov_b32 v71, 0
    v_mov_b32 v72, 0
    v_mov_b32 v73, 0
    v_mov_b32 v74, 0
    v_mov_b32 v75, 0
    v_mov_b32 v76, 0
    v_mov_b32 v77, 0
    v_mov_b32 v78, 0
    v_mov_b32 v79, 0
    v_mov_b32 v80, 0
    v_mov_b32 v81, 0
    v_mov_b32 v82, 0
    v_mov_b32 v83, 0
    s_barrier
    v_mov_b32 v84, 0
    v_mov_b32 v85, 0
    v_mov_b32 v86, 0
    v_mov_b32 v87, 0
    v_mov_b32 v88, 0
    v_mov_b32 v89, 0
    v_mov_b32 v90, 0
    v_mov_b32 v91, 0
    v_mov_b32 v92, 0
    v_mov_b32 v93, 0
    v_mov_b32 v94, 0
    v_mov_b32 v95, 0
    v_mov_b32 v144, 0
    v_mov_b32 v145, 0
    v_mov_b32 v146, 0
    v_mov_b32 v147, 0
    v_mov_b32 v148, 0
    v_mov_b32 v149, 0
    v_mov_b32 v150, 0
    v_mov_b32 v151, 0
    v_mov_b32 v152, 0
    v_mov_b32 v153, 0
    v_mov_b32 v154, 0
    v_mov_b32 v155, 0
    v_mov_b32 v156, 0
    v_mov_b32 v157, 0
    v_mov_b32 v158, 0
    v_mov_b32 v159, 0
    v_mov_b32 v216, 0
    v_mov_b32 v217, 0
    v_mov_b32 v218, 0
    v_mov_b32 v219, 0
    v_mov_b32 v220, 0
    v_mov_b32 v221, 0
    v_mov_b32 v222, 0
    v_mov_b32 v223, 0
    v_mov_b32 v224, 0xdddd
    s_lshr_b32 s13, s7, 3
    s_lshl_b32 s14, s13, 3
    s_lshl_b32 s81, 0xff, s14
    s_xor_b32 s83, s81, 0xffff
    s_lshl_b32 s11, s6, 6
    s_lshl_b32 s12, s3, 3
    s_add_u32 s12, s12, s11
    s_lshl_b32 s13, s13, 5
    s_add_u32 s12, s12, s13
    s_lshl_b32 s12, s12, 12
    v_add_u32 v231, s12, v250
    s_and_b32 s12, s7, 7
    s_lshl_b32 s73, s12, 12
    s_lshl_b32 s12, s7, 2
    s_add_u32 s11, s11, s12
    s_lshl_b32 s11, s11, 11
    s_add_u32 s74, s11, 0x400000
    s_add_u32 s11, s3, 1
    s_and_b32 s11, s11, 3
    s_mul_i32 s11, s11, 12288
    s_add_u32 s11, s11, 0
    v_add_u32 v225, s11, v250
    s_add_u32 s11, s3, 2
    s_and_b32 s11, s11, 3
    s_mul_i32 s11, s11, 12288
    s_add_u32 s11, s11, 4096
    v_add_u32 v226, s11, v250
    s_add_u32 s11, s3, 3
    s_and_b32 s11, s11, 3
    s_mul_i32 s11, s11, 12288
    s_add_u32 s11, s11, 8192
    v_add_u32 v227, s11, v250
    s_mov_b32 s72, 0
    s_mov_b32 s79, 0
    s_barrier
    s_waitcnt vmcnt(0)
    s_mov_b32 s89, 1048576
Lln_3_n1:
    v_readfirstlane_b32 s10, v240
    s_nop 1
    s_cmp_lg_u32 s10, 0
    s_cbranch_scc1 Lln_3_n2
    s_sub_u32 s89, s89, 1
    s_cbranch_scc1 Lln_3_n2
    buffer_load_dword v240, v252, s[68:71], 0 offen sc1
    s_waitcnt vmcnt(0)
    s_branch Lln_3_n1
Lln_3_n2:
    v_mov_b32 v242, s10
    s_mov_b64 exec, 1
    buffer_store_dword v242, v241, s[52:55], 0 offen sc1
    s_mov_b64 exec, -1
    s_lshr_b32 s11, s10, 1
    s_xor_b32 s11, s11, s2
    s_and_b32 s11, s11, 1
    s_lshr_b32 s12, s2, 3
    s_mul_i32 s38, s11, 32
    s_add_u32 s38, s38, s12
    s_mul_i32 s13, s38, 147
    s_lshr_b32 s13, s13, 10
    s_mul_i32 s9, s13, 7
    s_sub_u32 s9, s38, s9
    s_bfe_u32 s38, s2, 0x20001
    s_lshl_b32 s38, s38, 3
    s_add_u32 s8, s38, s13
    s_mul_i32 s11, s11, 8
    s_add_u32 s12, s12, s11
    s_cmp_lt_u32 s12, 32
    s_cselect_b32 s88, 1, 0
    s_barrier
    s_mov_b32 s48, s24
    s_mov_b32 s49, s25
    s_mov_b32 s50, 0x188000
    s_mov_b32 s51, 0x20000
    s_mov_b32 s60, s26
    s_mov_b32 s61, s27
    s_mov_b32 s62, 0x188000
    s_mov_b32 s63, 0x20000
    v_add_u32 v236, 128, v236
    v_add_u32 v237, 128, v237
    s_add_u32 s11, s82, 2
    s_sub_u32 s12, s11, 7
    s_cselect_b32 s11, s11, s12
    s_mul_i32 s75, s11, 229376
    s_barrier
    s_add_u32 m0, s15, 114688
    s_nop 0
    buffer_load_dwordx4 v236, s[48:51], s75 offen lds
    s_add_u32 m0, s15, 118784
    s_nop 0
    buffer_load_dwordx4 v237, s[60:63], s75 offen lds
    s_add_u32 s75, s75, 114688
    s_cmp_eq_u32 s75, 1605632
    s_cselect_b32 s75, 0, s75
    s_add_u32 m0, s15, 122880
    s_nop 0
    buffer_load_dwordx4 v236, s[48:51], s75 offen lds
    s_add_u32 m0, s15, 126976
    s_nop 0
    buffer_load_dwordx4 v237, s[60:63], s75 offen lds
    s_add_u32 s75, s75, 114688
    s_cmp_eq_u32 s75, 1605632
    s_cselect_b32 s75, 0, s75
    s_barrier
    s_add_u32 m0, s15, 131072
    s_nop 0
    buffer_load_dwordx4 v236, s[48:51], s75 offen lds
    s_add_u32 m0, s15, 135168
    s_nop 0
    buffer_load_dwordx4 v237, s[60:63], s75 offen lds
    s_add_u32 s75, s75, 114688
    s_cmp_eq_u32 s75, 1605632
    s_cselect_b32 s75, 0, s75
    s_add_u32 m0, s15, 139264
    s_nop 0
    buffer_load_dwordx4 v236, s[48:51], s75 offen lds
    s_add_u32 m0, s15, 143360
    s_nop 0
    buffer_load_dwordx4 v237, s[60:63], s75 offen lds
    s_add_u32 s75, s75, 114688
    s_cmp_eq_u32 s75, 1605632
    s_cselect_b32 s75, 0, s75
    s_waitcnt vmcnt(4)
    s_barrier
    s_add_u32 m0, s15, 147456
    s_nop 0
    buffer_load_dwordx4 v236, s[48:51], s75 offen lds
    s_add_u32 m0, s15, 151552
    s_nop 0
    buffer_load_dwordx4 v237, s[60:63], s75 offen lds
    s_add_u32 s75, s75, 114688
    s_cmp_eq_u32 s75, 1605632
    s_cselect_b32 s75, 0, s75
    s_add_u32 m0, s15, 155648
    s_nop 0
    buffer_load_dwordx4 v236, s[48:51], s75 offen lds
    s_add_u32 m0, s15, 159744
    s_nop 0
    buffer_load_dwordx4 v237, s[60:63], s75 offen lds
    s_add_u32 s75, s75, 114688
    s_cmp_eq_u32 s75, 1605632
    s_cselect_b32 s75, 0, s75
    s_waitcnt vmcnt(4)
    s_barrier
    s_add_u32 m0, s15, 114688
    s_nop 0
    buffer_load_dwordx4 v236, s[48:51], s75 offen lds
    s_add_u32 m0, s15, 118784
    s_nop 0
    buffer_load_dwordx4 v237, s[60:63], s75 offen lds
    s_add_u32 s75, s75, 114688
    s_cmp_eq_u32 s75, 1605632
    s_cselect_b32 s75, 0, s75
    s_add_u32 m0, s15, 122880
    s_nop 0
    buffer_load_dwordx4 v236, s[48:51], s75 offen lds
    s_add_u32 m0, s15, 126976
    s_nop 0
    buffer_load_dwordx4 v237, s[60:63], s75 offen lds
    s_add_u32 s75, s75, 114688
    s_cmp_eq_u32 s75, 1605632
    s_cselect_b32 s75, 0, s75
    buffer_load_dword v244, v243, s[52:55], 0 offen sc1
    s_waitcnt vmcnt(4)
    s_barrier
    s_add_u32 m0, s15, 131072
    s_nop 0
    buffer_load_dwordx4 v236, s[48:51], s75 offen lds
    s_add_u32 m0, s15, 135168
    s_nop 0
    buffer_load_dwordx4 v237, s[60:63], s75 offen lds
    s_add_u32 s75, s75, 114688
    s_cmp_eq_u32 s75, 1605632
    s_cselect_b32 s75, 0, s75
    s_add_u32 m0, s15, 139264
    s_nop 0
    buffer_load_dwordx4 v236, s[48:51], s75 offen lds
    s_add_u32 m0, s15, 143360
    s_nop 0
    buffer_load_dwordx4 v237, s[60:63], s75 offen lds
    s_add_u32 s75, s75, 114688
    s_cmp_eq_u32 s75, 1605632
    s_cselect_b32 s75, 0, s75
    s_waitcnt vmcnt(4)
    s_barrier
    v_cmp_ne_u32 vcc, s10, v244
    s_mov_b32 s84, s83
    s_lshr_b64 s[12:13], vcc, 16
    s_cbranch_scc1 Lnotyet_4
    s_and_b32 s12, vcc_lo, s81
    s_cbranch_scc1 Lnotyet_4
    s_and_b32 s12, vcc_lo, s84
    s_cselect_b32 s97, 0, 99
    buffer_load_dwordx4 v[160:163], v231, s[52:55], s73 offen offset:0 sc1
    buffer_load_dwordx4 v[164:167], v231, s[52:55], s73 offen offset:1024 sc1
    s_add_u32 s11, s3, 1
    s_and_b32 s11, s11, 3
    s_lshl_b32 s11, s11, 11
    s_add_u32 s11, s11, s74
    buffer_load_dwordx4 v[0:3], v250, s[52:55], s11 offen offset:0 sc1
    buffer_load_dwordx4 v[4:7], v250, s[52:55], s11 offen offset:1024 sc1
    s_add_u32 s11, s3, 2
    s_and_b32 s11, s11, 3
    s_lshl_b32 s11, s11, 11
    s_add_u32 s11, s11, s74
    buffer_load_dwordx4 v[8:11], v250, s[52:55], s11 offen offset:0 sc1
    buffer_load_dwordx4 v[12:15], v250, s[52:55], s11 offen offset:1024 sc1
    s_add_u32 s11, s3, 3
    s_and_b32 s11, s11, 3
    s_lshl_b32 s11, s11, 11
    s_add_u32 s11, s11, s74
    buffer_load_dwordx4 v[16:19], v250, s[52:55], s11 offen offset:0 sc1
    buffer_load_dwordx4 v[20:23], v250, s[52:55], s11 offen offset:1024 sc1
    s_add_u32 s11, s3, 4
    s_and_b32 s11, s11, 3
    s_lshl_b32 s11, s11, 11
    s_add_u32 s11, s11, s74
    buffer_load_dwordx4 v[24:27], v250, s[52:55], s11 offen offset:0 sc1
    buffer_load_dwordx4 v[28:31], v250, s[52:55], s11 offen offset:1024 sc1
    s_waitcnt vmcnt(10)
    s_barrier
    buffer_load_dwordx4 v[168:171], v231, s[52:55], s73 offen offset:2048 sc1
    buffer_load_dwordx4 v[172:175], v231, s[52:55], s73 offen offset:3072 sc1
    s_add_u32 s73, s73, 4096
    s_and_b32 s73, s73, 0x7fff
    buffer_load_dwordx4 v[176:179], v231, s[52:55], s73 offen offset:0 sc1
    buffer_load_dwordx4 v[180:183], v231, s[52:55], s73 offen offset:1024 sc1
    buffer_load_dwordx4 v[184:187], v231, s[52:55], s73 offen offset:2048 sc1
    buffer_load_dwordx4 v[188:191], v231, s[52:55], s73 offen offset:3072 sc1
    s_add_u32 s73, s73, 4096
    s_and_b32 s73, s73, 0x7fff
    buffer_load_dwordx4 v[192:195], v231, s[52:55], s73 offen offset:0 sc1
    buffer_load_dwordx4 v[196:199], v231, s[52:55], s73 offen offset:1024 sc1
    buffer_load_dwordx4 v[200:203], v231, s[52:55], s73 offen offset:2048 sc1
    buffer_load_dwordx4 v[204:207], v231, s[52:55], s73 offen offset:3072 sc1
    v_lshlrev_b32 v245, 2, v251
    v_add_u32 v245, 160768, v245
    ds_write_b32 v245, v252
    s_lshl_b32 s11, s3, 2
    s_add_u32 s11, s11, 160832
    v_mov_b32 v228, s11
    s_waitcnt lgkmcnt(0)
    s_barrier
    s_setprio 2
    s_branch Lstart
Lnotyet_4:
    s_waitcnt vmcnt(0)
    s_barrier
    v_lshlrev_b32 v245, 2, v251
    v_add_u32 v245, 160768, v245
    ds_write_b32 v245, v252
    s_lshl_b32 s11, s3, 2
    s_add_u32 s11, s11, 160832
    v_mov_b32 v228, s11
    s_waitcnt lgkmcnt(0)
    s_barrier
    s_branch Lready
Lpa_s_entry:
    s_mov_b32 s98, 0x0fffffff
    s_mov_b32 s99, 0x0fffffff
    v_and_b32 v28, 31, v251
    v_mul_u32_u24 v27, 37, v28
    v_lshrrev_b32 v27, 8, v27
    v_mul_u32_u24 v29, 7, v27
    v_sub_u32 v29, v28, v29
    v_cmp_lt_u32 vcc, 27, v28
    v_mov_b32 v24, 7
    s_nop 0
    v_cndmask_b32 v27, v27, v29, vcc
    v_cndmask_b32 v29, v29, v24, vcc
    v_lshrrev_b32 v24, 1, v27
    v_lshlrev_b32 v24, 4, v24
    v_and_b32 v27, 1, v27
    v_lshl_add_u32 v24, v27, 2, v24
    v_lshrrev_b32 v27, 2, v29
    v_lshl_add_u32 v24, v27, 3, v24
    v_and_b32 v29, 3, v29
    v_add_u32 v24, v24, v29
    v_and_b32 v27, 32, v251
    v_add_u32 v24, v24, v27
    v_lshlrev_b32 v234, 4, v24
    v_cmp_eq_u32 vcc, 31, v28
    v_mov_b32 v27, 0x3f803f80
    s_lshl_b32 s11, s38, 6
    v_cndmask_b32 v192, v252, v27, vcc
    s_add_u32 s11, s11, s77
    s_lshl_b32 s76, s11, 12
    s_add_u32 s78, s76, 4096
    v_mov_b32 v193, v192
    v_mov_b32 v194, v192
    v_mov_b32 v195, v192
    v_mov_b32 v196, v192
    v_mov_b32 v197, v192
    v_mov_b32 v198, v192
    v_mov_b32 v199, v192
    v_mov_b32 v200, v192
    v_mov_b32 v201, v192
    v_mov_b32 v202, v192
    v_mov_b32 v203, v192
    v_mov_b32 v204, v192
    v_mov_b32 v205, v192
    v_mov_b32 v206, v192
    v_mov_b32 v207, v192
    v_mov_b32 v208, v192
    v_mov_b32 v209, v192
    v_mov_b32 v210, v192
    v_mov_b32 v211, v192
    v_mov_b32 v212, v192
    v_mov_b32 v213, v192
    v_mov_b32 v214, v192
    v_mov_b32 v215, v192
    v_mov_b32 v216, v192
    v_mov_b32 v217, v192
    v_mov_b32 v218, v192
    v_mov_b32 v219, v192
    v_mov_b32 v220, v192
    v_mov_b32 v221, v192
    v_mov_b32 v222, v192
    v_mov_b32 v223, v192
    v_mov_b32 v128, 0
    v_mov_b32 v129, 0
    v_mov_b32 v130, 0
    v_mov_b32 v131, 0
    v_mov_b32 v132, 0
    v_mov_b32 v133, 0
    v_mov_b32 v134, 0
    v_mov_b32 v135, 0
    v_mov_b32 v136, 0
    v_mov_b32 v137, 0
    v_mov_b32 v138, 0
    v_mov_b32 v139, 0
    v_mov_b32 v140, 0
    v_mov_b32 v141, 0
    v_mov_b32 v142, 0
    v_mov_b32 v143, 0
    v_mov_b32 v144, 0
    v_mov_b32 v145, 0
    v_mov_b32 v146, 0
    v_mov_b32 v147, 0
    v_mov_b32 v148, 0
    v_mov_b32 v149, 0
    v_mov_b32 v150, 0
    v_mov_b32 v151, 0
    v_mov_b32 v152, 0
    v_mov_b32 v153, 0
    v_mov_b32 v154, 0
    v_mov_b32 v155, 0
    v_mov_b32 v156, 0
    v_mov_b32 v157, 0
    v_mov_b32 v158, 0
    v_mov_b32 v159, 0
    v_mov_b32 v160, 0
    v_mov_b32 v161, 0
    v_mov_b32 v162, 0
    v_mov_b32 v163, 0
    v_mov_b32 v164, 0
    v_mov_b32 v165, 0
    v_mov_b32 v166, 0
    v_mov_b32 v167, 0
    v_mov_b32 v168, 0
    v_mov_b32 v169, 0
    v_mov_b32 v170, 0
    v_mov_b32 v171, 0
    v_mov_b32 v172, 0
    v_mov_b32 v173, 0
    v_mov_b32 v174, 0
    v_mov_b32 v175, 0
    v_mov_b32 v176, 0
    v_mov_b32 v177, 0
    v_mov_b32 v178, 0
    v_mov_b32 v179, 0
    v_mov_b32 v180, 0
    v_mov_b32 v181, 0
    v_mov_b32 v182, 0
    v_mov_b32 v183, 0
    v_mov_b32 v184, 0
    v_mov_b32 v185, 0
    v_mov_b32 v186, 0
    v_mov_b32 v187, 0
    v_mov_b32 v188, 0
    v_mov_b32 v189, 0
    v_mov_b32 v190, 0
    v_mov_b32 v191, 0
    s_and_b32 s12, s92, 15
    s_lshl_b32 s12, s12, 12
    s_add_u32 s12, s12, 114688
    s_lshr_b64 s[92:93], s[92:93], 4
    v_add_u32 v4, s12, v1
    v_add_u32 v5, s12, v2
    v_add_u32 v6, s12, v3
    v_add_u32 v11, s84, v10
    v_cndmask_b32 v4, v4, v11, s[94:95]
    s_or_b32 s11, s81, 0
    v_xor_b32 v8, s11, v7
    v_xor_b32 v9, 32, v8
    s_waitcnt lgkmcnt(0)
    s_barrier
.p2align 5
Lpa_s:
    v_mfma_f32_32x32x16_bf16 v[96:111], v[64:67], v[56:59], v[96:111]
    ds_read_b128 v[16:19], v8 offset:0
    ds_read_b128 v[20:23], v8 offset:4096
    ds_read_b64_tr_b16 v[24:25], v4 offset:0
    v_mfma_f32_32x32x16_bf16 v[112:127], v[64:67], v[60:63], v[112:127]
    ds_read_b64_tr_b16 v[26:27], v4 offset:512
    ds_read_b64_tr_b16 v[28:29], v5 offset:0
    ds_read_b64_tr_b16 v[30:31], v5 offset:1024
    v_mfma_f32_32x32x16_bf16 v[128:143], v[56:59], v[68:71], v[128:143]
    ds_read_b64_tr_b16 v[32:33], v6 offset:0
    ds_read_b64_tr_b16 v[34:35], v6 offset:1024
    ds_read_b128 v[36:39], v9 offset:0
    v_mfma_f32_32x32x16_bf16 v[144:159], v[60:63], v[68:71], v[144:159]
    ds_read_b128 v[40:43], v9 offset:4096
    ds_read_b64_tr_b16 v[44:45], v4 offset:2048
    ds_read_b64_tr_b16 v[46:47], v4 offset:2560
    v_mfma_f32_32x32x16_bf16 v[160:175], v[56:59], v[72:75], v[160:175]
    ds_read_b64_tr_b16 v[48:49], v5 offset:4096
    ds_read_b64_tr_b16 v[50:51], v5 offset:5120
    ds_read_b64_tr_b16 v[52:53], v6 offset:4096
    v_mfma_f32_32x32x16_bf16 v[176:191], v[60:63], v[72:75], v[176:191]
    ds_read_b64_tr_b16 v[54:55], v6 offset:5120
    s_add_u32 s84, s84, 64
    s_and_b32 s12, s92, 15
    s_lshl_b32 s12, s12, 12
    s_add_u32 s12, s12, 114688
    v_mfma_f32_32x32x16_bf16 v[96:111], v[84:87], v[76:79], v[96:111]
    s_lshr_b64 s[92:93], s[92:93], 4
    v_add_u32 v4, s12, v1
    v_add_u32 v5, s12, v2
    v_add_u32 v6, s12, v3
    v_mfma_f32_32x32x16_bf16 v[112:127], v[84:87], v[80:83], v[112:127]
    v_add_u32 v11, s84, v10
    v_cndmask_b32 v4, v4, v11, s[94:95]
    s_or_b32 s11, s81, 64
    v_xor_b32 v8, s11, v7
    v_mfma_f32_32x32x16_bf16 v[128:143], v[76:79], v[88:91], v[128:143]
    v_xor_b32 v9, 32, v8
    v_mfma_f32_32x32x16_bf16 v[144:159], v[80:83], v[88:91], v[144:159]
    v_mfma_f32_32x32x16_bf16 v[160:175], v[76:79], v[92:95], v[160:175]
    s_waitcnt lgkmcnt(0)
    s_barrier
    v_mfma_f32_32x32x16_bf16 v[176:191], v[80:83], v[92:95], v[176:191]
    v_mfma_f32_32x32x16_bf16 v[96:111], v[24:27], v[16:19], v[96:111]
    ds_read_b128 v[56:59], v8 offset:0
    ds_read_b128 v[60:63], v8 offset:4096
    ds_read_b64_tr_b16 v[64:65], v4 offset:0
    v_mfma_f32_32x32x16_bf16 v[112:127], v[24:27], v[20:23], v[112:127]
    ds_read_b64_tr_b16 v[66:67], v4 offset:512
    ds_read_b64_tr_b16 v[68:69], v5 offset:0
    ds_read_b64_tr_b16 v[70:71], v5 offset:1024
    v_mfma_f32_32x32x16_bf16 v[128:143], v[16:19], v[28:31], v[128:143]
    ds_read_b64_tr_b16 v[72:73], v6 offset:0
    ds_read_b64_tr_b16 v[74:75], v6 offset:1024
    ds_read_b128 v[76:79], v9 offset:0
    v_mfma_f32_32x32x16_bf16 v[144:159], v[20:23], v[28:31], v[144:159]
    ds_read_b128 v[80:83], v9 offset:4096
    ds_read_b64_tr_b16 v[84:85], v4 offset:2048
    ds_read_b64_tr_b16 v[86:87], v4 offset:2560
    v_mfma_f32_32x32x16_bf16 v[160:175], v[16:19], v[32:35], v[160:175]
    ds_read_b64_tr_b16 v[88:89], v5 offset:4096
    ds_read_b64_tr_b16 v[90:91], v5 offset:5120
    ds_read_b64_tr_b16 v[92:93], v6 offset:4096
    v_mfma_f32_32x32x16_bf16 v[176:191], v[20:23], v[32:35], v[176:191]
    ds_read_b64_tr_b16 v[94:95], v6 offset:5120
    s_add_u32 s84, s84, 64
    s_cmp_eq_u32 s84, 160256
    s_cselect_b32 s84, 160768, s84
    s_cmp_eq_u32 s84, 161152
    s_cselect_b32 s84, 159744, s84
    v_mfma_f32_32x32x16_bf16 v[96:111], v[44:47], v[36:39], v[96:111]
    s_add_u32 s81, s81, 16384
    s_cmp_eq_u32 s81, 114688
    s_cselect_b32 s81, 0, s81
    s_and_b32 s12, s92, 15
    s_lshl_b32 s12, s12, 12
    v_mfma_f32_32x32x16_bf16 v[112:127], v[44:47], v[40:43], v[112:127]
    s_add_u32 s12, s12, 114688
    s_lshr_b64 s[92:93], s[92:93], 4
    v_add_u32 v4, s12, v1
    v_add_u32 v5, s12, v2
    v_add_u32 v6, s12, v3
    v_mfma_f32_32x32x16_bf16 v[128:143], v[36:39], v[48:51], v[128:143]
    v_add_u32 v11, s84, v10
    v_cndmask_b32 v4, v4, v11, s[94:95]
    s_or_b32 s11, s81, 0
    v_xor_b32 v8, s11, v7
    v_xor_b32 v9, 32, v8
    v_mfma_f32_32x32x16_bf16 v[144:159], v[40:43], v[48:51], v[144:159]
    s_add_u32 s72, s72, 1
    s_cmp_lg_u32 s72, 4
    s_cbranch_scc1 Lpa_s_n
    buffer_load_dword v240, v252, s[68:71], 0 offen sc1
Lpa_s_n:
    s_cmp_lt_u32 s72, 7
    v_mfma_f32_32x32x16_bf16 v[160:175], v[36:39], v[52:55], v[160:175]
    s_waitcnt lgkmcnt(0)
    s_barrier
    v_mfma_f32_32x32x16_bf16 v[176:191], v[40:43], v[52:55], v[176:191]
    s_cbranch_scc1 Lpa_s
    s_mov_b32 s80, 0
    v_mfma_f32_32x32x16_bf16 v[96:111], v[64:67], v[56:59], v[96:111]
    v_mfma_f32_32x32x16_bf16 v[112:127], v[64:67], v[60:63], v[112:127]
    v_mfma_f32_32x32x16_bf16 v[128:143], v[56:59], v[68:71], v[128:143]
    v_mfma_f32_32x32x16_bf16 v[144:159], v[60:63], v[68:71], v[144:159]
    v_mfma_f32_32x32x16_bf16 v[160:175], v[56:59], v[72:75], v[160:175]
    v_mfma_f32_32x32x16_bf16 v[176:191], v[60:63], v[72:75], v[176:191]
    v_mfma_f32_32x32x16_bf16 v[96:111], v[84:87], v[76:79], v[96:111]
    v_mfma_f32_32x32x16_bf16 v[112:127], v[84:87], v[80:83], v[112:127]
    v_mfma_f32_32x32x16_bf16 v[128:143], v[76:79], v[88:91], v[128:143]
    v_mfma_f32_32x32x16_bf16 v[144:159], v[80:83], v[88:91], v[144:159]
    v_mfma_f32_32x32x16_bf16 v[160:175], v[76:79], v[92:95], v[160:175]
    v_mfma_f32_32x32x16_bf16 v[176:191], v[80:83], v[92:95], v[176:191]
    s_nop 6
    v_mov_b32 v16, v108
    v_mov_b32 v17, v124
    v_mul_f32 v96, s96, v96
    v_mul_f32 v97, s96, v97
    v_mul_f32 v98, s96, v98
    v_mul_f32 v99, s96, v99
    v_mul_f32 v100, s96, v100
    v_mul_f32 v101, s96, v101
    v_permlane32_swap_b32 v16, v17
    v_mul_f32 v102, s96, v102
    v_mul_f32 v103, s96, v103
    v_cvt_pk_bf16_f32 v76, v96, v97
    v_cvt_pk_bf16_f32 v77, v98, v99
    v_cvt_pk_bf16_f32 v17, v17, v17
    v_cvt_pk_bf16_f32 v78, v100, v101
    v_and_b32 v17, 0xffff0000, v17
    v_cvt_pk_bf16_f32 v79, v102, v103
    v_mul_f32 v17, 0xbfb8aa3b, v17
    buffer_store_dwordx4 v[76:79], v233, s[52:55], s0 offen sc1
    v_exp_f32 v17, v17
    v_mul_f32 v112, s96, v112
    v_mul_f32 v113, s96, v113
    v_add_f32 v17, 1.0, v17
    v_mul_f32 v114, s96, v114
    v_mul_f32 v115, s96, v115
    v_rcp_f32 v17, v17
    v_mul_f32 v116, s96, v116
    v_mul_f32 v117, s96, v117
    v_cvt_pk_bf16_f32 v18, v17, v17
    v_mul_f32 v118, s96, v118
    v_mul_f32 v119, s96, v119
    v_and_b32 v17, 0xffff0000, v18
    v_cvt_pk_bf16_f32 v84, v112, v113
    v_and_b32 v18, s23, v18
    v_cvt_pk_bf16_f32 v85, v114, v115
    v_sub_f32 v17, 1.0, v17
    v_cvt_pk_bf16_f32 v86, v116, v117
    v_mov_b32 v19, v18
    v_cvt_pk_bf16_f32 v87, v118, v119
    v_cvt_pk_bf16_f32 v17, v17, v17
    buffer_store_dwordx4 v[84:87], v233, s[52:55], s1 offen sc1
    v_and_b32 v17, 0xffff0000, v17
    v_mul_f32 v104, s96, v104
    v_mul_f32 v105, s96, v105
    v_permlane32_swap_b32 v18, v19
    v_mul_f32 v106, s96, v106
    v_mul_f32 v107, s96, v107
    v_rcp_f32 v20, v17
    v_mul_f32 v108, s96, v108
    v_mul_f32 v109, s96, v109
    v_min_f32 v20, 0x7f000000, v20
    v_mul_f32 v110, s96, v110
    v_mul_f32 v111, s96, v111
    buffer_store_dword v20, v232, s[52:55], 0 offen sc1
    v_cvt_pk_bf16_f32 v80, v104, v105
    v_cvt_pk_bf16_f32 v81, v106, v107
    v_cvt_pk_bf16_f32 v82, v108, v109
    v_cvt_pk_bf16_f32 v83, v110, v111
    v_cndmask_b32 v83, v83, v252, s[90:91]
    v_mul_f32 v120, s96, v120
    v_mul_f32 v121, s96, v121
    v_mul_f32 v122, s96, v122
    v_mul_f32 v123, s96, v123
    s_barrier
    v_mul_f32 v124, s96, v124
    v_mul_f32 v125, s96, v125
    v_mul_f32 v126, s96, v126
    v_mul_f32 v127, s96, v127
    v_cvt_pk_bf16_f32 v88, v120, v121
    v_cvt_pk_bf16_f32 v89, v122, v123
    v_cvt_pk_bf16_f32 v90, v124, v125
    v_cvt_pk_bf16_f32 v91, v126, v127
    v_cndmask_b32 v91, v91, v252, s[90:91]
    v_cndmask_b32 v82, v82, v18, s[90:91]
    buffer_store_dwordx4 v[80:83], v233, s[52:55], s0 offen offset:1024 sc1
    v_cndmask_b32 v90, v90, v19, s[90:91]
    buffer_store_dwordx4 v[88:91], v233, s[52:55], s1 offen offset:1024 sc1
    s_mov_b64 exec, s[98:99]
    v_cvt_pk_bf16_f32 v192, v128, v129
    v_cvt_pk_bf16_f32 v193, v130, v131
    v_cvt_pk_bf16_f32 v194, v132, v133
    v_cvt_pk_bf16_f32 v195, v134, v135
    v_cvt_pk_bf16_f32 v196, v136, v137
    v_cvt_pk_bf16_f32 v197, v138, v139
    v_cvt_pk_bf16_f32 v198, v140, v141
    v_cvt_pk_bf16_f32 v199, v142, v143
    s_mov_b64 exec, -1
    buffer_store_dwordx4 v[192:195], v234, s[52:55], s76 offen offset:2048 sc1
    buffer_store_dwordx4 v[196:199], v234, s[52:55], s76 offen offset:3072 sc1
    s_mov_b64 exec, s[98:99]
    v_cvt_pk_bf16_f32 v200, v144, v145
    v_cvt_pk_bf16_f32 v201, v146, v147
    v_cvt_pk_bf16_f32 v202, v148, v149
    v_cvt_pk_bf16_f32 v203, v150, v151
    v_cvt_pk_bf16_f32 v204, v152, v153
    v_cvt_pk_bf16_f32 v205, v154, v155
    v_cvt_pk_bf16_f32 v206, v156, v157
    v_cvt_pk_bf16_f32 v207, v158, v159
    s_mov_b64 exec, -1
    buffer_store_dwordx4 v[200:203], v234, s[52:55], s78 offen offset:2048 sc1
    buffer_store_dwordx4 v[204:207], v234, s[52:55], s78 offen offset:3072 sc1
    s_add_u32 s76, s76, 0x40000
    s_add_u32 s78, s78, 0x40000
    s_mov_b64 exec, s[98:99]
    v_cvt_pk_bf16_f32 v208, v160, v161
    v_cvt_pk_bf16_f32 v209, v162, v163
    v_cvt_pk_bf16_f32 v210, v164, v165
    v_cvt_pk_bf16_f32 v211, v166, v167
    v_cvt_pk_bf16_f32 v212, v168, v169
    v_cvt_pk_bf16_f32 v213, v170, v171
    v_cvt_pk_bf16_f32 v214, v172, v173
    v_cvt_pk_bf16_f32 v215, v174, v175
    s_mov_b64 exec, -1
    buffer_store_dwordx4 v[208:211], v234, s[52:55], s76 offen offset:2048 sc1
    buffer_store_dwordx4 v[212:215], v234, s[52:55], s76 offen offset:3072 sc1
    s_mov_b64 exec, s[98:99]
    v_cvt_pk_bf16_f32 v216, v176, v177
    v_cvt_pk_bf16_f32 v217, v178, v179
    v_cvt_pk_bf16_f32 v218, v180, v181
    v_cvt_pk_bf16_f32 v219, v182, v183
    v_cvt_pk_bf16_f32 v220, v184, v185
    v_cvt_pk_bf16_f32 v221, v186, v187
    v_cvt_pk_bf16_f32 v222, v188, v189
    v_cvt_pk_bf16_f32 v223, v190, v191
    s_mov_b64 exec, -1
    buffer_store_dwordx4 v[216:219], v234, s[52:55], s78 offen offset:2048 sc1
    buffer_store_dwordx4 v[220:223], v234, s[52:55], s78 offen offset:3072 sc1
    s_barrier
    v_and_b32 v16, 3, v251
    s_lshl_b32 s11, s3, 2
    v_add_u32 v16, s11, v16
    v_bfe_u32 v17, v251, 3, 1
    v_lshl_add_u32 v16, v17, 4, v16
    v_bfe_u32 v17, v251, 2, 1
    v_lshlrev_b32 v17, 4, v17
    s_add_u32 s12, s6, 16
    v_add_u32 v17, s12, v17
    v_lshl_add_u32 v16, v17, 5, v16
    s_lshl_b32 s11, s6, 5
    s_lshl_b32 s12, s7, 1
    s_add_u32 s11, s11, s12
    v_and_b32 v17, 1, v251
    v_add_u32 v17, s11, v17
    v_cmp_gt_u32 vcc, 16, v251
    s_mov_b32 s11, 0xf00000
    s_nop 0
    v_cndmask_b32 v16, v17, v16, vcc
    v_lshl_add_u32 v243, v16, 7, s11
    v_mov_b32 v32, 0
    v_mov_b32 v33, 0
    v_mov_b32 v34, 0
    v_mov_b32 v35, 0
    v_mov_b32 v36, 0
    v_mov_b32 v37, 0
    v_mov_b32 v38, 0
    v_mov_b32 v39, 0
    v_mov_b32 v40, 0
    v_mov_b32 v41, 0
    v_mov_b32 v42, 0
    v_mov_b32 v43, 0
    v_mov_b32 v44, 0
    v_mov_b32 v45, 0
    v_mov_b32 v46, 0
    v_mov_b32 v47, 0
    v_mov_b32 v48, 0
    v_mov_b32 v49, 0
    v_mov_b32 v50, 0
    v_mov_b32 v51, 0
    v_mov_b32 v52, 0
    v_mov_b32 v53, 0
    v_mov_b32 v54, 0
    v_mov_b32 v55, 0
    v_mov_b32 v56, 0
    v_mov_b32 v57, 0
    v_mov_b32 v58, 0
    v_mov_b32 v59, 0
    v_mov_b32 v60, 0
    v_mov_b32 v61, 0
    v_mov_b32 v62, 0
    v_mov_b32 v63, 0
    v_mov_b32 v64, 0
    v_mov_b32 v65, 0
    v_mov_b32 v66, 0
    v_mov_b32 v67, 0
    v_mov_b32 v68, 0
    v_mov_b32 v69, 0
    v_mov_b32 v70, 0
    v_mov_b32 v71, 0
    v_mov_b32 v72, 0
    v_mov_b32 v73, 0
    v_mov_b32 v74, 0
    v_mov_b32 v75, 0
    v_mov_b32 v76, 0
    v_mov_b32 v77, 0
    v_mov_b32 v78, 0
    v_mov_b32 v79, 0
    v_mov_b32 v80, 0
    v_mov_b32 v81, 0
    v_mov_b32 v82, 0
    v_mov_b32 v83, 0
    s_cmp_lg_u32 s80, 0
    s_cbranch_scc1 Lout_10
    s_mov_b32 s11, 12
Llook_9:
    s_getreg_b32 s12, hwreg(HW_REG_IB_STS)
    s_and_b32 s12, s12, 0xc000000f
    s_cbranch_scc0 Lout_10_go
    s_sub_u32 s11, s11, 1
    s_cbranch_scc0 Llook_9
    s_branch Lout_10
Lout_10_go:
    s_waitcnt vmcnt(0)
    s_mov_b32 s89, 1048576
Lln_11_n1:
    v_readfirstlane_b32 s10, v240
    s_nop 1
    s_cmp_lg_u32 s10, 0
    s_cbranch_scc1 Lln_11_n2
    s_sub_u32 s89, s89, 1
    s_cbranch_scc1 Lln_11_n2
    buffer_load_dword v240, v252, s[68:71], 0 offen sc1
    s_waitcnt vmcnt(0)
    s_branch Lln_11_n1
Lln_11_n2:
    v_mov_b32 v242, s10
    s_mov_b64 exec, 7
    buffer_store_dword v242, v241, s[52:55], 0 offen sc1
    s_mov_b64 exec, -1
    s_mov_b32 s80, 1
Lout_10:
    s_barrier
    v_mov_b32 v84, 0
    v_mov_b32 v85, 0
    v_mov_b32 v86, 0
    v_mov_b32 v87, 0
    v_mov_b32 v88, 0
    v_mov_b32 v89, 0
    v_mov_b32 v90, 0
    v_mov_b32 v91, 0
    v_mov_b32 v92, 0
    v_mov_b32 v93, 0
    v_mov_b32 v94, 0
    v_mov_b32 v95, 0
    v_mov_b32 v144, 0
    v_mov_b32 v145, 0
    v_mov_b32 v146, 0
    v_mov_b32 v147, 0
    v_mov_b32 v148, 0
    v_mov_b32 v149, 0
    v_mov_b32 v150, 0
    v_mov_b32 v151, 0
    v_mov_b32 v152, 0
    v_mov_b32 v153, 0
    v_mov_b32 v154, 0
    v_mov_b32 v155, 0
    v_mov_b32 v156, 0
    v_mov_b32 v157, 0
    v_mov_b32 v158, 0
    v_mov_b32 v159, 0
    v_mov_b32 v216, 0
    v_mov_b32 v217, 0
    v_mov_b32 v218, 0
    v_mov_b32 v219, 0
    v_mov_b32 v220, 0
    v_mov_b32 v221, 0
    v_mov_b32 v222, 0
    v_mov_b32 v223, 0
    v_mov_b32 v224, 0xdddd
    s_lshr_b32 s13, s7, 3
    s_lshl_b32 s14, s13, 3
    s_lshl_b32 s81, 0xff, s14
    s_xor_b32 s83, s81, 0xffff
    s_lshl_b32 s11, s6, 6
    s_lshl_b32 s12, s3, 3
    s_add_u32 s12, s12, s11
    s_lshl_b32 s13, s13, 5
    s_add_u32 s12, s12, s13
    s_lshl_b32 s12, s12, 12
    v_add_u32 v231, s12, v250
    s_and_b32 s12, s7, 7
    s_lshl_b32 s73, s12, 12
    s_lshl_b32 s12, s7, 2
    s_add_u32 s11, s11, s12
    s_lshl_b32 s11, s11, 11
    s_add_u32 s74, s11, 0x400000
    s_add_u32 s11, s3, 1
    s_and_b32 s11, s11, 3
    s_mul_i32 s11, s11, 12288
    s_add_u32 s11, s11, 0
    v_add_u32 v225, s11, v250
    s_add_u32 s11, s3, 2
    s_and_b32 s11, s11, 3
    s_mul_i32 s11, s11, 12288
    s_add_u32 s11, s11, 4096
    v_add_u32 v226, s11, v250
    s_add_u32 s11, s3, 3
    s_and_b32 s11, s11, 3
    s_mul_i32 s11, s11, 12288
    s_add_u32 s11, s11, 8192
    v_add_u32 v227, s11, v250
    s_mov_b32 s72, 0
    s_mov_b32 s79, 0
    s_cmp_lg_u32 s80, 0
    s_cbranch_scc1 Lout_13
    s_mov_b32 s11, 12
Llook_12:
    s_getreg_b32 s12, hwreg(HW_REG_IB_STS)
    s_and_b32 s12, s12, 0xc000000f
    s_cbranch_scc0 Lout_13_go
    s_sub_u32 s11, s11, 1
    s_cbranch_scc0 Llook_12
    s_branch Lout_13
Lout_13_go:
    s_waitcnt vmcnt(0)
    s_mov_b32 s89, 1048576
Lln_14_n1:
    v_readfirstlane_b32 s10, v240
    s_nop 1
    s_cmp_lg_u32 s10, 0
    s_cbranch_scc1 Lln_14_n2
    s_sub_u32 s89, s89, 1
    s_cbranch_scc1 Lln_14_n2
    buffer_load_dword v240, v252, s[68:71], 0 offen sc1
    s_waitcnt vmcnt(0)
    s_branch Lln_14_n1
Lln_14_n2:
    v_mov_b32 v242, s10
    s_mov_b64 exec, 7
    buffer_store_dword v242, v241, s[52:55], 0 offen sc1
    s_mov_b64 exec, -1
    s_mov_b32 s80, 1
Lout_13:
    s_barrier
    s_cmp_lg_u32 s80, 0
    s_cbranch_scc1 Lout_15
    s_waitcnt vmcnt(0)
    s_mov_b32 s89, 1048576
Lln_7_n1:
    v_readfirstlane_b32 s10, v240
    s_nop 1
    s_cmp_lg_u32 s10, 0
    s_cbranch_scc1 Lln_7_n2
    s_sub_u32 s89, s89, 1
    s_cbranch_scc1 Lln_7_n2
    buffer_load_dword v240, v252, s[68:71], 0 offen sc1
    s_waitcnt vmcnt(0)
    s_branch Lln_7_n1
Lln_7_n2:
    v_mov_b32 v242, s10
    s_mov_b64 exec, 7
    buffer_store_dword v242, v241, s[52:55], 0 offen sc1
    s_mov_b64 exec, -1
Lout_15:
    s_lshr_b32 s11, s10, 1
    s_xor_b32 s11, s11, s2
    s_and_b32 s11, s11, 1
    s_lshr_b32 s12, s2, 3
    s_mul_i32 s38, s11, 32
    s_add_u32 s38, s38, s12
    s_mul_i32 s13, s38, 147
    s_lshr_b32 s13, s13, 10
    s_mul_i32 s9, s13, 7
    s_sub_u32 s9, s38, s9
    s_bfe_u32 s38, s2, 0x20001
    s_lshl_b32 s38, s38, 3
    s_add_u32 s8, s38, s13
    s_mul_i32 s11, s11, 8
    s_add_u32 s12, s12, s11
    s_cmp_lt_u32 s12, 32
    s_cselect_b32 s88, 1, 0
    buffer_load_dword v244, v243, s[52:55], 0 offen sc1
    s_waitcnt vmcnt(0)
    s_barrier
    v_cmp_ne_u32 vcc, s10, v244
    s_mov_b32 s84, s83
    s_lshr_b64 s[12:13], vcc, 16
    s_cbranch_scc1 Lnotyet_16
    s_and_b32 s12, vcc_lo, s81
    s_cbranch_scc1 Lnotyet_16
    s_and_b32 s12, vcc_lo, s84
    s_cselect_b32 s97, 0, 99
    buffer_load_dwordx4 v[160:163], v231, s[52:55], s73 offen offset:0 sc1
    buffer_load_dwordx4 v[164:167], v231, s[52:55], s73 offen offset:1024 sc1
    s_add_u32 s11, s3, 1
    s_and_b32 s11, s11, 3
    s_lshl_b32 s11, s11, 11
    s_add_u32 s11, s11, s74
    buffer_load_dwordx4 v[0:3], v250, s[52:55], s11 offen offset:0 sc1
    buffer_load_dwordx4 v[4:7], v250, s[52:55], s11 offen offset:1024 sc1
    s_add_u32 s11, s3, 2
    s_and_b32 s11, s11, 3
    s_lshl_b32 s11, s11, 11
    s_add_u32 s11, s11, s74
    buffer_load_dwordx4 v[8:11], v250, s[52:55], s11 offen offset:0 sc1
    buffer_load_dwordx4 v[12:15], v250, s[52:55], s11 offen offset:1024 sc1
    s_add_u32 s11, s3, 3
    s_and_b32 s11, s11, 3
    s_lshl_b32 s11, s11, 11
    s_add_u32 s11, s11, s74
    buffer_load_dwordx4 v[16:19], v250, s[52:55], s11 offen offset:0 sc1
    buffer_load_dwordx4 v[20:23], v250, s[52:55], s11 offen offset:1024 sc1
    s_add_u32 s11, s3, 4
    s_and_b32 s11, s11, 3
    s_lshl_b32 s11, s11, 11
    s_add_u32 s11, s11, s74
    buffer_load_dwordx4 v[24:27], v250, s[52:55], s11 offen offset:0 sc1
    buffer_load_dwordx4 v[28:31], v250, s[52:55], s11 offen offset:1024 sc1
    s_waitcnt vmcnt(10)
    s_barrier
    buffer_load_dwordx4 v[168:171], v231, s[52:55], s73 offen offset:2048 sc1
    buffer_load_dwordx4 v[172:175], v231, s[52:55], s73 offen offset:3072 sc1
    s_add_u32 s73, s73, 4096
    s_and_b32 s73, s73, 0x7fff
    buffer_load_dwordx4 v[176:179], v231, s[52:55], s73 offen offset:0 sc1
    buffer_load_dwordx4 v[180:183], v231, s[52:55], s73 offen offset:1024 sc1
    buffer_load_dwordx4 v[184:187], v231, s[52:55], s73 offen offset:2048 sc1
    buffer_load_dwordx4 v[188:191], v231, s[52:55], s73 offen offset:3072 sc1
    s_add_u32 s73, s73, 4096
    s_and_b32 s73, s73, 0x7fff
    buffer_load_dwordx4 v[192:195], v231, s[52:55], s73 offen offset:0 sc1
    buffer_load_dwordx4 v[196:199], v231, s[52:55], s73 offen offset:1024 sc1
    buffer_load_dwordx4 v[200:203], v231, s[52:55], s73 offen offset:2048 sc1
    buffer_load_dwordx4 v[204:207], v231, s[52:55], s73 offen offset:3072 sc1
    v_lshlrev_b32 v245, 2, v251
    v_add_u32 v245, 160768, v245
    ds_write_b32 v245, v252
    s_lshl_b32 s11, s3, 2
    s_add_u32 s11, s11, 160832
    v_mov_b32 v228, s11
    s_waitcnt lgkmcnt(0)
    s_barrier
    s_barrier
    s_setprio 2
    s_branch Lstart
Lnotyet_16:
    s_waitcnt vmcnt(0)
    s_barrier
    v_lshlrev_b32 v245, 2, v251
    v_add_u32 v245, 160768, v245
    ds_write_b32 v245, v252
    s_lshl_b32 s11, s3, 2
    s_add_u32 s11, s11, 160832
    v_mov_b32 v228, s11
    s_waitcnt lgkmcnt(0)
    s_barrier
    s_barrier
Lready:
    s_setprio 2
    s_mov_b32 s89, 1048576
    s_branch Lpoll_kv
Lpoll_kv_again:
    s_sub_u32 s89, s89, 1
    s_cbranch_scc1 Lstart
    s_sleep 1
Lpoll_kv:
    buffer_load_dword v244, v243, s[52:55], 0 offen sc1
    s_waitcnt vmcnt(0)
    v_cmp_ne_u32 vcc, s10, v244
    s_mov_b32 s84, s83
    s_lshr_b64 s[12:13], vcc, 16
    s_cbranch_scc1 Lpoll_kv_again
    s_and_b32 s12, vcc_lo, s81
    s_cbranch_scc1 Lpoll_kv_again
    s_and_b32 s12, vcc_lo, s84
    s_cselect_b32 s97, 0, 99
    buffer_load_dwordx4 v[160:163], v231, s[52:55], s73 offen offset:0 sc1
    buffer_load_dwordx4 v[164:167], v231, s[52:55], s73 offen offset:1024 sc1
    s_add_u32 s11, s3, 1
    s_and_b32 s11, s11, 3
    s_lshl_b32 s11, s11, 11
    s_add_u32 s11, s11, s74
    buffer_load_dwordx4 v[0:3], v250, s[52:55], s11 offen offset:0 sc1
    buffer_load_dwordx4 v[4:7], v250, s[52:55], s11 offen offset:1024 sc1
    s_add_u32 s11, s3, 2
    s_and_b32 s11, s11, 3
    s_lshl_b32 s11, s11, 11
    s_add_u32 s11, s11, s74
    buffer_load_dwordx4 v[8:11], v250, s[52:55], s11 offen offset:0 sc1
    buffer_load_dwordx4 v[12:15], v250, s[52:55], s11 offen offset:1024 sc1
    s_add_u32 s11, s3, 3
    s_and_b32 s11, s11, 3
    s_lshl_b32 s11, s11, 11
    s_add_u32 s11, s11, s74
    buffer_load_dwordx4 v[16:19], v250, s[52:55], s11 offen offset:0 sc1
    buffer_load_dwordx4 v[20:23], v250, s[52:55], s11 offen offset:1024 sc1
    s_add_u32 s11, s3, 4
    s_and_b32 s11, s11, 3
    s_lshl_b32 s11, s11, 11
    s_add_u32 s11, s11, s74
    buffer_load_dwordx4 v[24:27], v250, s[52:55], s11 offen offset:0 sc1
    buffer_load_dwordx4 v[28:31], v250, s[52:55], s11 offen offset:1024 sc1
    buffer_load_dwordx4 v[168:171], v231, s[52:55], s73 offen offset:2048 sc1
    buffer_load_dwordx4 v[172:175], v231, s[52:55], s73 offen offset:3072 sc1
    s_add_u32 s73, s73, 4096
    s_and_b32 s73, s73, 0x7fff
    buffer_load_dwordx4 v[176:179], v231, s[52:55], s73 offen offset:0 sc1
    buffer_load_dwordx4 v[180:183], v231, s[52:55], s73 offen offset:1024 sc1
    buffer_load_dwordx4 v[184:187], v231, s[52:55], s73 offen offset:2048 sc1
    buffer_load_dwordx4 v[188:191], v231, s[52:55], s73 offen offset:3072 sc1
    s_add_u32 s73, s73, 4096
    s_and_b32 s73, s73, 0x7fff
    buffer_load_dwordx4 v[192:195], v231, s[52:55], s73 offen offset:0 sc1
    buffer_load_dwordx4 v[196:199], v231, s[52:55], s73 offen offset:1024 sc1
    buffer_load_dwordx4 v[200:203], v231, s[52:55], s73 offen offset:2048 sc1
    buffer_load_dwordx4 v[204:207], v231, s[52:55], s73 offen offset:3072 sc1
Lstart:
    s_waitcnt vmcnt(8)
Lattn:
    v_mfma_f32_32x32x16_bf16 v[96:111], v[160:163], v[0:3], 0
    v_mfma_f32_32x32x16_bf16 v[96:111], v[164:167], v[4:7], v[96:111]
    s_nop 10
.p2align 5
Lattn_loop:
    v_mfma_f32_32x32x16_bf16 v[112:127], v[160:163], v[8:11], 0
    v_exp_f32 v96, v96
    v_exp_f32 v97, v97
    v_exp_f32 v98, v98
    v_mfma_f32_32x32x16_bf16 v[112:127], v[164:167], v[12:15], v[112:127]
    s_add_u32 s73, s73, 4096
    v_exp_f32 v99, v99
    v_exp_f32 v100, v100
    v_exp_f32 v101, v101
    v_smfmac_f32_32x32x32_bf16 v[80:95], v[216:219], v[144:151], v224
    s_and_b32 s73, s73, 0x7fff
    v_exp_f32 v102, v102
    v_exp_f32 v103, v103
    v_exp_f32 v104, v104
    v_smfmac_f32_32x32x32_bf16 v[80:95], v[220:223], v[152:159], v224
    buffer_load_dwordx4 v[208:211], v231, s[52:55], s73 offen offset:0 sc1
    buffer_load_dwordx4 v[212:215], v231, s[52:55], s73 offen offset:1024 sc1
    buffer_load_dwordx4 v[216:219], v231, s[52:55], s73 offen offset:2048 sc1
    buffer_load_dwordx4 v[220:223], v231, s[52:55], s73 offen offset:3072 sc1
    v_exp_f32 v105, v105
    v_exp_f32 v106, v106
    v_exp_f32 v107, v107
    v_exp_f32 v108, v108
    v_exp_f32 v109, v109
    v_exp_f32 v110, v110
    v_exp_f32 v111, v111
    v_mfma_f32_32x32x16_bf16 v[128:143], v[160:163], v[16:19], 0
    v_exp_f32 v112, v112
    v_exp_f32 v113, v113
    v_exp_f32 v114, v114
    v_mfma_f32_32x32x16_bf16 v[128:143], v[164:167], v[20:23], v[128:143]
    v_exp_f32 v115, v115
    v_exp_f32 v116, v116
    v_exp_f32 v117, v117
    v_smfmac_f32_32x32x32_bf16 v[32:47], v[168:171], v[96:103], v224
    v_exp_f32 v118, v118
    v_exp_f32 v119, v119
    v_exp_f32 v120, v120
    v_smfmac_f32_32x32x32_bf16 v[32:47], v[172:175], v[104:111], v224
    v_exp_f32 v121, v121
    v_exp_f32 v122, v122
    v_exp_f32 v123, v123
    v_exp_f32 v124, v124
    v_exp_f32 v125, v125
    v_exp_f32 v126, v126
    v_exp_f32 v127, v127
    v_mfma_f32_32x32x16_bf16 v[144:159], v[160:163], v[24:27], 0
    v_exp_f32 v128, v128
    v_exp_f32 v129, v129
    v_exp_f32 v130, v130
    v_mfma_f32_32x32x16_bf16 v[144:159], v[164:167], v[28:31], v[144:159]
    v_exp_f32 v131, v131
    v_exp_f32 v132, v132
    v_exp_f32 v133, v133
    v_smfmac_f32_32x32x32_bf16 v[48:63], v[168:171], v[112:119], v224
    v_exp_f32 v134, v134
    v_exp_f32 v135, v135
    v_exp_f32 v136, v136
    v_smfmac_f32_32x32x32_bf16 v[48:63], v[172:175], v[120:127], v224
    s_waitcnt vmcnt(8)
    v_exp_f32 v137, v137
    v_exp_f32 v138, v138
    v_exp_f32 v139, v139
    v_exp_f32 v140, v140
    v_exp_f32 v141, v141
    v_exp_f32 v142, v142
    v_exp_f32 v143, v143
    v_mfma_f32_32x32x16_bf16 v[96:111], v[176:179], v[0:3], 0
    v_exp_f32 v144, v144
    v_exp_f32 v145, v145
    v_exp_f32 v146, v146
    v_mfma_f32_32x32x16_bf16 v[96:111], v[180:183], v[4:7], v[96:111]
    s_cmp_lg_u32 s72, 1
    v_exp_f32 v147, v147
    v_exp_f32 v148, v148
    v_exp_f32 v149, v149
    v_smfmac_f32_32x32x32_bf16 v[64:79], v[168:171], v[128:135], v224
    s_cbranch_scc0 Lswitch
Lswitched:
    v_exp_f32 v150, v150
    v_exp_f32 v151, v151
    v_exp_f32 v152, v152
    v_smfmac_f32_32x32x32_bf16 v[64:79], v[172:175], v[136:143], v224
    v_exp_f32 v153, v153
    v_exp_f32 v154, v154
    v_exp_f32 v155, v155
    v_exp_f32 v156, v156
    v_exp_f32 v157, v157
    v_exp_f32 v158, v158
    v_exp_f32 v159, v159
    v_mfma_f32_32x32x16_bf16 v[112:127], v[176:179], v[8:11], 0
    v_exp_f32 v96, v96
    v_exp_f32 v97, v97
    v_exp_f32 v98, v98
    v_mfma_f32_32x32x16_bf16 v[112:127], v[180:183], v[12:15], v[112:127]
    s_add_u32 s73, s73, 4096
    v_exp_f32 v99, v99
    v_exp_f32 v100, v100
    v_exp_f32 v101, v101
    v_smfmac_f32_32x32x32_bf16 v[80:95], v[168:171], v[144:151], v224
    s_and_b32 s73, s73, 0x7fff
    v_exp_f32 v102, v102
    v_exp_f32 v103, v103
    v_exp_f32 v104, v104
    v_smfmac_f32_32x32x32_bf16 v[80:95], v[172:175], v[152:159], v224
    buffer_load_dwordx4 v[160:163], v231, s[52:55], s73 offen offset:0 sc1
    buffer_load_dwordx4 v[164:167], v231, s[52:55], s73 offen offset:1024 sc1
    buffer_load_dwordx4 v[168:171], v231, s[52:55], s73 offen offset:2048 sc1
    buffer_load_dwordx4 v[172:175], v231, s[52:55], s73 offen offset:3072 sc1
    v_exp_f32 v105, v105
    v_exp_f32 v106, v106
    v_exp_f32 v107, v107
    v_exp_f32 v108, v108
    v_exp_f32 v109, v109
    v_exp_f32 v110, v110
    v_exp_f32 v111, v111
    v_mfma_f32_32x32x16_bf16 v[128:143], v[176:179], v[16:19], 0
    v_exp_f32 v112, v112
    v_exp_f32 v113, v113
    v_exp_f32 v114, v114
    v_mfma_f32_32x32x16_bf16 v[128:143], v[180:183], v[20:23], v[128:143]
    v_exp_f32 v115, v115
    v_exp_f32 v116, v116
    v_exp_f32 v117, v117
    v_smfmac_f32_32x32x32_bf16 v[32:47], v[184:187], v[96:103], v224
    v_exp_f32 v118, v118
    v_exp_f32 v119, v119
    v_exp_f32 v120, v120
    v_smfmac_f32_32x32x32_bf16 v[32:47], v[188:191], v[104:111], v224
    v_exp_f32 v121, v121
    v_exp_f32 v122, v122
    v_exp_f32 v123, v123
    v_exp_f32 v124, v124
    v_exp_f32 v125, v125
    v_exp_f32 v126, v126
    v_exp_f32 v127, v127
    v_mfma_f32_32x32x16_bf16 v[144:159], v[176:179], v[24:27], 0
    v_exp_f32 v128, v128
    v_exp_f32 v129, v129
    v_exp_f32 v130, v130
    v_mfma_f32_32x32x16_bf16 v[144:159], v[180:183], v[28:31], v[144:159]
    v_exp_f32 v131, v131
    v_exp_f32 v132, v132
    v_exp_f32 v133, v133
    v_smfmac_f32_32x32x32_bf16 v[48:63], v[184:187], v[112:119], v224
    v_exp_f32 v134, v134
    v_exp_f32 v135, v135
    v_exp_f32 v136, v136
    v_smfmac_f32_32x32x32_bf16 v[48:63], v[188:191], v[120:127], v224
    s_waitcnt vmcnt(8)
    v_exp_f32 v137, v137
    v_exp_f32 v138, v138
    v_exp_f32 v139, v139
    v_exp_f32 v140, v140
    v_exp_f32 v141, v141
    v_exp_f32 v142, v142
    v_exp_f32 v143, v143
    v_mfma_f32_32x32x16_bf16 v[96:111], v[192:195], v[0:3], 0
    v_exp_f32 v144, v144
    v_exp_f32 v145, v145
    v_exp_f32 v146, v146
    v_mfma_f32_32x32x16_bf16 v[96:111], v[196:199], v[4:7], v[96:111]
    v_exp_f32 v147, v147
    v_exp_f32 v148, v148
    v_exp_f32 v149, v149
    v_smfmac_f32_32x32x32_bf16 v[64:79], v[184:187], v[128:135], v224
    v_exp_f32 v150, v150
    v_exp_f32 v151, v151
    v_exp_f32 v152, v152
    v_smfmac_f32_32x32x32_bf16 v[64:79], v[188:191], v[136:143], v224
    v_exp_f32 v153, v153
    v_exp_f32 v154, v154
    v_exp_f32 v155, v155
    v_exp_f32 v156, v156
    v_exp_f32 v157, v157
    v_exp_f32 v158, v158
    v_exp_f32 v159, v159
    v_mfma_f32_32x32x16_bf16 v[112:127], v[192:195], v[8:11], 0
    v_exp_f32 v96, v96
    v_exp_f32 v97, v97
    v_exp_f32 v98, v98
    v_mfma_f32_32x32x16_bf16 v[112:127], v[196:199], v[12:15], v[112:127]
    s_add_u32 s73, s73, 4096
    v_exp_f32 v99, v99
    v_exp_f32 v100, v100
    v_exp_f32 v101, v101
    v_smfmac_f32_32x32x32_bf16 v[80:95], v[184:187], v[144:151], v224
    s_and_b32 s73, s73, 0x7fff
    v_exp_f32 v102, v102
    v_exp_f32 v103, v103
    v_exp_f32 v104, v104
    v_smfmac_f32_32x32x32_bf16 v[80:95], v[188:191], v[152:159], v224
    buffer_load_dwordx4 v[176:179], v231, s[52:55], s73 offen offset:0 sc1
    buffer_load_dwordx4 v[180:183], v231, s[52:55], s73 offen offset:1024 sc1
    buffer_load_dwordx4 v[184:187], v231, s[52:55], s73 offen offset:2048 sc1
    buffer_load_dwordx4 v[188:191], v231, s[52:55], s73 offen offset:3072 sc1
    v_exp_f32 v105, v105
    v_exp_f32 v106, v106
    v_exp_f32 v107, v107
    v_exp_f32 v108, v108
    v_exp_f32 v109, v109
    v_exp_f32 v110, v110
    v_exp_f32 v111, v111
    v_mfma_f32_32x32x16_bf16 v[128:143], v[192:195], v[16:19], 0
    v_exp_f32 v112, v112
    v_exp_f32 v113, v113
    v_exp_f32 v114, v114
    v_mfma_f32_32x32x16_bf16 v[128:143], v[196:199], v[20:23], v[128:143]
    v_exp_f32 v115, v115
    v_exp_f32 v116, v116
    v_exp_f32 v117, v117
    v_smfmac_f32_32x32x32_bf16 v[32:47], v[200:203], v[96:103], v224
    v_exp_f32 v118, v118
    v_exp_f32 v119, v119
    v_exp_f32 v120, v120
    v_smfmac_f32_32x32x32_bf16 v[32:47], v[204:207], v[104:111], v224
    v_exp_f32 v121, v121
    v_exp_f32 v122, v122
    v_exp_f32 v123, v123
    v_exp_f32 v124, v124
    v_exp_f32 v125, v125
    v_exp_f32 v126, v126
    v_exp_f32 v127, v127
    v_mfma_f32_32x32x16_bf16 v[144:159], v[192:195], v[24:27], 0
    v_exp_f32 v128, v128
    v_exp_f32 v129, v129
    v_exp_f32 v130, v130
    v_mfma_f32_32x32x16_bf16 v[144:159], v[196:199], v[28:31], v[144:159]
    v_exp_f32 v131, v131
    v_exp_f32 v132, v132
    v_exp_f32 v133, v133
    v_smfmac_f32_32x32x32_bf16 v[48:63], v[200:203], v[112:119], v224
    v_exp_f32 v134, v134
    v_exp_f32 v135, v135
    v_exp_f32 v136, v136
    v_smfmac_f32_32x32x32_bf16 v[48:63], v[204:207], v[120:127], v224
    s_waitcnt vmcnt(8)
    v_exp_f32 v137, v137
    v_exp_f32 v138, v138
    v_exp_f32 v139, v139
    v_exp_f32 v140, v140
    v_exp_f32 v141, v141
    v_exp_f32 v142, v142
    v_exp_f32 v143, v143
    v_mfma_f32_32x32x16_bf16 v[96:111], v[208:211], v[0:3], 0
    v_exp_f32 v144, v144
    v_exp_f32 v145, v145
    v_exp_f32 v146, v146
    v_mfma_f32_32x32x16_bf16 v[96:111], v[212:215], v[4:7], v[96:111]
    s_cmp_lg_u32 s72, s97
    v_exp_f32 v147, v147
    v_exp_f32 v148, v148
    v_exp_f32 v149, v149
    v_smfmac_f32_32x32x32_bf16 v[64:79], v[200:203], v[128:135], v224
    s_cbranch_scc1 Lno_repoll
    buffer_load_dword v244, v243, s[52:55], 0 offen sc1
Lno_repoll:
    v_exp_f32 v150, v150
    v_exp_f32 v151, v151
    v_exp_f32 v152, v152
    v_smfmac_f32_32x32x32_bf16 v[64:79], v[204:207], v[136:143], v224
    v_exp_f32 v153, v153
    v_exp_f32 v154, v154
    v_exp_f32 v155, v155
    v_exp_f32 v156, v156
    v_exp_f32 v157, v157
    v_exp_f32 v158, v158
    v_exp_f32 v159, v159
    v_mfma_f32_32x32x16_bf16 v[112:127], v[208:211], v[8:11], 0
    v_exp_f32 v96, v96
    v_exp_f32 v97, v97
    v_exp_f32 v98, v98
    v_mfma_f32_32x32x16_bf16 v[112:127], v[212:215], v[12:15], v[112:127]
    s_add_u32 s73, s73, 4096
    v_exp_f32 v99, v99
    v_exp_f32 v100, v100
    v_exp_f32 v101, v101
    v_smfmac_f32_32x32x32_bf16 v[80:95], v[200:203], v[144:151], v224
    s_and_b32 s73, s73, 0x7fff
    v_exp_f32 v102, v102
    v_exp_f32 v103, v103
    v_exp_f32 v104, v104
    v_smfmac_f32_32x32x32_bf16 v[80:95], v[204:207], v[152:159], v224
    buffer_load_dwordx4 v[192:195], v231, s[52:55], s73 offen offset:0 sc1
    buffer_load_dwordx4 v[196:199], v231, s[52:55], s73 offen offset:1024 sc1
    buffer_load_dwordx4 v[200:203], v231, s[52:55], s73 offen offset:2048 sc1
    buffer_load_dwordx4 v[204:207], v231, s[52:55], s73 offen offset:3072 sc1
    v_exp_f32 v105, v105
    v_exp_f32 v106, v106
    v_exp_f32 v107, v107
    v_exp_f32 v108, v108
    v_exp_f32 v109, v109
    v_exp_f32 v110, v110
    v_exp_f32 v111, v111
    v_mfma_f32_32x32x16_bf16 v[128:143], v[208:211], v[16:19], 0
    v_exp_f32 v112, v112
    v_exp_f32 v113, v113
    v_exp_f32 v114, v114
    v_mfma_f32_32x32x16_bf16 v[128:143], v[212:215], v[20:23], v[128:143]
    v_exp_f32 v115, v115
    v_exp_f32 v116, v116
    v_exp_f32 v117, v117
    v_smfmac_f32_32x32x32_bf16 v[32:47], v[216:219], v[96:103], v224
    v_exp_f32 v118, v118
    v_exp_f32 v119, v119
    v_exp_f32 v120, v120
    v_smfmac_f32_32x32x32_bf16 v[32:47], v[220:223], v[104:111], v224
    v_exp_f32 v121, v121
    v_exp_f32 v122, v122
    v_exp_f32 v123, v123
    v_exp_f32 v124, v124
    v_exp_f32 v125, v125
    v_exp_f32 v126, v126
    v_exp_f32 v127, v127
    v_mfma_f32_32x32x16_bf16 v[144:159], v[208:211], v[24:27], 0
    v_exp_f32 v128, v128
    v_exp_f32 v129, v129
    v_exp_f32 v130, v130
    v_mfma_f32_32x32x16_bf16 v[144:159], v[212:215], v[28:31], v[144:159]
    v_exp_f32 v131, v131
    v_exp_f32 v132, v132
    v_exp_f32 v133, v133
    v_smfmac_f32_32x32x32_bf16 v[48:63], v[216:219], v[112:119], v224
    v_exp_f32 v134, v134
    v_exp_f32 v135, v135
    v_exp_f32 v136, v136
    v_smfmac_f32_32x32x32_bf16 v[48:63], v[220:223], v[120:127], v224
    s_waitcnt vmcnt(8)
    v_exp_f32 v137, v137
    v_exp_f32 v138, v138
    v_exp_f32 v139, v139
    v_exp_f32 v140, v140
    v_exp_f32 v141, v141
    v_exp_f32 v142, v142
    v_exp_f32 v143, v143
    v_mfma_f32_32x32x16_bf16 v[96:111], v[160:163], v[0:3], 0
    v_exp_f32 v144, v144
    v_exp_f32 v145, v145
    v_exp_f32 v146, v146
    v_mfma_f32_32x32x16_bf16 v[96:111], v[164:167], v[4:7], v[96:111]
    s_add_u32 s72, s72, 1
    v_exp_f32 v147, v147
    v_exp_f32 v148, v148
    v_exp_f32 v149, v149
    v_smfmac_f32_32x32x32_bf16 v[64:79], v[216:219], v[128:135], v224
    s_cmp_lt_u32 s72, 3
    v_exp_f32 v150, v150
    v_exp_f32 v151, v151
    v_exp_f32 v152, v152
    v_smfmac_f32_32x32x32_bf16 v[64:79], v[220:223], v[136:143], v224
    v_exp_f32 v153, v153
    v_exp_f32 v154, v154
    v_exp_f32 v155, v155
    v_exp_f32 v156, v156
    v_exp_f32 v157, v157
    v_exp_f32 v158, v158
    v_exp_f32 v159, v159
    s_cbranch_scc1 Lattn_loop
    v_mfma_f32_32x32x16_bf16 v[112:127], v[160:163], v[8:11], 0
    v_exp_f32 v96, v96
    v_exp_f32 v97, v97
    v_exp_f32 v98, v98
    v_mfma_f32_32x32x16_bf16 v[112:127], v[164:167], v[12:15], v[112:127]
    s_add_u32 s73, s73, 4096
    v_exp_f32 v99, v99
    v_exp_f32 v100, v100
    v_exp_f32 v101, v101
    v_smfmac_f32_32x32x32_bf16 v[80:95], v[216:219], v[144:151], v224
    s_and_b32 s73, s73, 0x7fff
    v_exp_f32 v102, v102
    v_exp_f32 v103, v103
    v_exp_f32 v104, v104
    v_smfmac_f32_32x32x32_bf16 v[80:95], v[220:223], v[152:159], v224
    buffer_load_dwordx4 v[208:211], v231, s[52:55], s73 offen offset:0 sc1
    buffer_load_dwordx4 v[212:215], v231, s[52:55], s73 offen offset:1024 sc1
    buffer_load_dwordx4 v[216:219], v231, s[52:55], s73 offen offset:2048 sc1
    buffer_load_dwordx4 v[220:223], v231, s[52:55], s73 offen offset:3072 sc1
    v_exp_f32 v105, v105
    v_exp_f32 v106, v106
    v_exp_f32 v107, v107
    v_exp_f32 v108, v108
    v_exp_f32 v109, v109
    v_exp_f32 v110, v110
    v_exp_f32 v111, v111
    v_mfma_f32_32x32x16_bf16 v[128:143], v[160:163], v[16:19], 0
    v_exp_f32 v112, v112
    v_exp_f32 v113, v113
    v_exp_f32 v114, v114
    v_mfma_f32_32x32x16_bf16 v[128:143], v[164:167], v[20:23], v[128:143]
    v_exp_f32 v115, v115
    v_exp_f32 v116, v116
    v_exp_f32 v117, v117
    v_smfmac_f32_32x32x32_bf16 v[32:47], v[168:171], v[96:103], v224
    v_exp_f32 v118, v118
    v_exp_f32 v119, v119
    v_exp_f32 v120, v120
    v_smfmac_f32_32x32x32_bf16 v[32:47], v[172:175], v[104:111], v224
    s_waitcnt vmcnt(8)
    v_exp_f32 v121, v121
    v_exp_f32 v122, v122
    v_exp_f32 v123, v123
    v_exp_f32 v124, v124
    v_exp_f32 v125, v125
    v_exp_f32 v126, v126
    v_exp_f32 v127, v127
    v_mfma_f32_32x32x16_bf16 v[144:159], v[176:179], v[0:3], 0
    v_exp_f32 v128, v128
    v_exp_f32 v129, v129
    v_exp_f32 v130, v130
    v_mfma_f32_32x32x16_bf16 v[144:159], v[180:183], v[4:7], v[144:159]
    v_exp_f32 v131, v131
    v_exp_f32 v132, v132
    v_exp_f32 v133, v133
    v_smfmac_f32_32x32x32_bf16 v[48:63], v[168:171], v[112:119], v224
    v_exp_f32 v134, v134
    v_exp_f32 v135, v135
    v_exp_f32 v136, v136
    v_smfmac_f32_32x32x32_bf16 v[48:63], v[172:175], v[120:127], v224
    s_waitcnt vmcnt(4)
    v_exp_f32 v137, v137
    v_exp_f32 v138, v138
    v_exp_f32 v139, v139
    v_exp_f32 v140, v140
    v_exp_f32 v141, v141
    v_exp_f32 v142, v142
    v_exp_f32 v143, v143
    v_mfma_f32_32x32x16_bf16 v[96:111], v[192:195], v[0:3], 0
    v_exp_f32 v144, v144
    v_exp_f32 v145, v145
    v_exp_f32 v146, v146
    v_mfma_f32_32x32x16_bf16 v[96:111], v[196:199], v[4:7], v[96:111]
    v_exp_f32 v147, v147
    v_exp_f32 v148, v148
    v_exp_f32 v149, v149
    v_smfmac_f32_32x32x32_bf16 v[64:79], v[168:171], v[128:135], v224
    v_exp_f32 v150, v150
    v_exp_f32 v151, v151
    v_exp_f32 v152, v152
    v_smfmac_f32_32x32x32_bf16 v[64:79], v[172:175], v[136:143], v224
    s_waitcnt vmcnt(0)
    v_exp_f32 v153, v153
    v_exp_f32 v154, v154
    v_exp_f32 v155, v155
    v_exp_f32 v156, v156
    v_exp_f32 v157, v157
    v_exp_f32 v158, v158
    v_exp_f32 v159, v159
    v_mfma_f32_32x32x16_bf16 v[112:127], v[208:211], v[0:3], 0
    v_exp_f32 v96, v96
    v_exp_f32 v97, v97
    v_exp_f32 v98, v98
    v_mfma_f32_32x32x16_bf16 v[112:127], v[212:215], v[4:7], v[112:127]
    v_exp_f32 v99, v99
    v_exp_f32 v100, v100
    v_exp_f32 v101, v101
    v_smfmac_f32_32x32x32_bf16 v[32:47], v[184:187], v[144:151], v224
    v_exp_f32 v102, v102
    v_exp_f32 v103, v103
    v_exp_f32 v104, v104
    v_smfmac_f32_32x32x32_bf16 v[32:47], v[188:191], v[152:159], v224
    v_exp_f32 v105, v105
    v_exp_f32 v106, v106
    v_exp_f32 v107, v107
    v_exp_f32 v108, v108
    v_exp_f32 v109, v109
    v_exp_f32 v110, v110
    v_exp_f32 v111, v111
    v_mfma_f32_32x32x16_bf16 v[128:143], v[176:179], v[8:11], 0
    v_exp_f32 v112, v112
    v_exp_f32 v113, v113
    v_exp_f32 v114, v114
    v_mfma_f32_32x32x16_bf16 v[128:143], v[180:183], v[12:15], v[128:143]
    v_exp_f32 v115, v115
    v_exp_f32 v116, v116
    v_exp_f32 v117, v117
    v_smfmac_f32_32x32x32_bf16 v[32:47], v[200:203], v[96:103], v224
    v_exp_f32 v118, v118
    v_exp_f32 v119, v119
    v_exp_f32 v120, v120
    v_smfmac_f32_32x32x32_bf16 v[32:47], v[204:207], v[104:111], v224
    v_exp_f32 v121, v121
    v_exp_f32 v122, v122
    v_exp_f32 v123, v123
    v_exp_f32 v124, v124
    v_exp_f32 v125, v125
    v_exp_f32 v126, v126
    v_exp_f32 v127, v127
    v_mfma_f32_32x32x16_bf16 v[144:159], v[192:195], v[8:11], 0
    v_exp_f32 v128, v128
    v_exp_f32 v129, v129
    v_exp_f32 v130, v130
    v_mfma_f32_32x32x16_bf16 v[144:159], v[196:199], v[12:15], v[144:159]
    v_exp_f32 v131, v131
    v_exp_f32 v132, v132
    v_exp_f32 v133, v133
    v_smfmac_f32_32x32x32_bf16 v[32:47], v[216:219], v[112:119], v224
    v_exp_f32 v134, v134
    v_exp_f32 v135, v135
    v_exp_f32 v136, v136
    v_smfmac_f32_32x32x32_bf16 v[32:47], v[220:223], v[120:127], v224
    v_exp_f32 v137, v137
    v_exp_f32 v138, v138
    v_exp_f32 v139, v139
    v_exp_f32 v140, v140
    v_exp_f32 v141, v141
    v_exp_f32 v142, v142
    v_exp_f32 v143, v143
    v_mfma_f32_32x32x16_bf16 v[96:111], v[208:211], v[8:11], 0
    v_exp_f32 v144, v144
    v_exp_f32 v145, v145
    v_exp_f32 v146, v146
    v_mfma_f32_32x32x16_bf16 v[96:111], v[212:215], v[12:15], v[96:111]
    ds_write_b128 v225, v[32:35] offset:0
    v_exp_f32 v147, v147
    v_exp_f32 v148, v148
    v_exp_f32 v149, v149
    v_smfmac_f32_32x32x32_bf16 v[48:63], v[184:187], v[128:135], v224
    ds_write_b128 v225, v[36:39] offset:1024
    v_exp_f32 v150, v150
    v_exp_f32 v151, v151
    v_exp_f32 v152, v152
    v_smfmac_f32_32x32x32_bf16 v[48:63], v[188:191], v[136:143], v224
    ds_write_b128 v225, v[40:43] offset:2048
    ds_write_b128 v225, v[44:47] offset:3072
    v_exp_f32 v153, v153
    v_exp_f32 v154, v154
    v_exp_f32 v155, v155
    v_exp_f32 v156, v156
    v_exp_f32 v157, v157
    v_exp_f32 v158, v158
    v_exp_f32 v159, v159
    v_mfma_f32_32x32x16_bf16 v[112:127], v[176:179], v[16:19], 0
    v_exp_f32 v96, v96
    v_exp_f32 v97, v97
    v_exp_f32 v98, v98
    v_mfma_f32_32x32x16_bf16 v[112:127], v[180:183], v[20:23], v[112:127]
    v_exp_f32 v99, v99
    v_exp_f32 v100, v100
    v_exp_f32 v101, v101
    v_smfmac_f32_32x32x32_bf16 v[48:63], v[200:203], v[144:151], v224
    v_exp_f32 v102, v102
    v_exp_f32 v103, v103
    v_exp_f32 v104, v104
    v_smfmac_f32_32x32x32_bf16 v[48:63], v[204:207], v[152:159], v224
    v_exp_f32 v105, v105
    v_exp_f32 v106, v106
    v_exp_f32 v107, v107
    v_exp_f32 v108, v108
    v_exp_f32 v109, v109
    v_exp_f32 v110, v110
    v_exp_f32 v111, v111
    v_mfma_f32_32x32x16_bf16 v[128:143], v[192:195], v[16:19], 0
    v_exp_f32 v112, v112
    v_exp_f32 v113, v113
    v_exp_f32 v114, v114
    v_mfma_f32_32x32x16_bf16 v[128:143], v[196:199], v[20:23], v[128:143]
    v_exp_f32 v115, v115
    v_exp_f32 v116, v116
    v_exp_f32 v117, v117
    v_smfmac_f32_32x32x32_bf16 v[48:63], v[216:219], v[96:103], v224
    v_exp_f32 v118, v118
    v_exp_f32 v119, v119
    v_exp_f32 v120, v120
    v_smfmac_f32_32x32x32_bf16 v[48:63], v[220:223], v[104:111], v224
    v_exp_f32 v121, v121
    v_exp_f32 v122, v122
    v_exp_f32 v123, v123
    v_exp_f32 v124, v124
    v_exp_f32 v125, v125
    v_exp_f32 v126, v126
    v_exp_f32 v127, v127
    v_mfma_f32_32x32x16_bf16 v[144:159], v[208:211], v[16:19], 0
    v_exp_f32 v128, v128
    v_exp_f32 v129, v129
    v_exp_f32 v130, v130
    v_mfma_f32_32x32x16_bf16 v[144:159], v[212:215], v[20:23], v[144:159]
    ds_write_b128 v226, v[48:51] offset:0
    v_exp_f32 v131, v131
    v_exp_f32 v132, v132
    v_exp_f32 v133, v133
    v_smfmac_f32_32x32x32_bf16 v[64:79], v[184:187], v[112:119], v224
    ds_write_b128 v226, v[52:55] offset:1024
    v_exp_f32 v134, v134
    v_exp_f32 v135, v135
    v_exp_f32 v136, v136
    v_smfmac_f32_32x32x32_bf16 v[64:79], v[188:191], v[120:127], v224
    ds_write_b128 v226, v[56:59] offset:2048
    ds_write_b128 v226, v[60:63] offset:3072
    v_exp_f32 v137, v137
    v_exp_f32 v138, v138
    v_exp_f32 v139, v139
    v_exp_f32 v140, v140
    v_exp_f32 v141, v141
    v_exp_f32 v142, v142
    v_exp_f32 v143, v143
    v_mfma_f32_32x32x16_bf16 v[96:111], v[160:163], v[24:27], 0
    v_exp_f32 v144, v144
    v_exp_f32 v145, v145
    v_exp_f32 v146, v146
    v_mfma_f32_32x32x16_bf16 v[96:111], v[164:167], v[28:31], v[96:111]
    v_exp_f32 v147, v147
    v_exp_f32 v148, v148
    v_exp_f32 v149, v149
    v_smfmac_f32_32x32x32_bf16 v[64:79], v[200:203], v[128:135], v224
    v_exp_f32 v150, v150
    v_exp_f32 v151, v151
    v_exp_f32 v152, v152
    v_smfmac_f32_32x32x32_bf16 v[64:79], v[204:207], v[136:143], v224
    v_exp_f32 v153, v153
    v_exp_f32 v154, v154
    v_exp_f32 v155, v155
    v_exp_f32 v156, v156
    v_exp_f32 v157, v157
    v_exp_f32 v158, v158
    v_exp_f32 v159, v159
    v_mfma_f32_32x32x16_bf16 v[112:127], v[176:179], v[24:27], 0
    s_mul_i32 s11, s3, 12288
    v_exp_f32 v96, v96
    v_exp_f32 v97, v97
    v_exp_f32 v98, v98
    v_mfma_f32_32x32x16_bf16 v[112:127], v[180:183], v[28:31], v[112:127]
    v_exp_f32 v99, v99
    v_exp_f32 v100, v100
    v_exp_f32 v101, v101
    v_smfmac_f32_32x32x32_bf16 v[64:79], v[216:219], v[144:151], v224
    v_exp_f32 v102, v102
    v_exp_f32 v103, v103
    v_exp_f32 v104, v104
    v_smfmac_f32_32x32x32_bf16 v[64:79], v[220:223], v[152:159], v224
    v_exp_f32 v105, v105
    v_exp_f32 v106, v106
    v_exp_f32 v107, v107
    v_exp_f32 v108, v108
    v_exp_f32 v109, v109
    v_exp_f32 v110, v110
    v_exp_f32 v111, v111
    v_mfma_f32_32x32x16_bf16 v[128:143], v[192:195], v[24:27], 0
    v_exp_f32 v112, v112
    v_exp_f32 v113, v113
    v_exp_f32 v114, v114
    v_mfma_f32_32x32x16_bf16 v[128:143], v[196:199], v[28:31], v[128:143]
    ds_write_b128 v227, v[64:67] offset:0
    v_exp_f32 v115, v115
    v_exp_f32 v116, v116
    v_exp_f32 v117, v117
    v_smfmac_f32_32x32x32_bf16 v[80:95], v[168:171], v[96:103], v224
    ds_write_b128 v227, v[68:71] offset:1024
    v_exp_f32 v118, v118
    v_exp_f32 v119, v119
    v_exp_f32 v120, v120
    v_smfmac_f32_32x32x32_bf16 v[80:95], v[172:175], v[104:111], v224
    ds_write_b128 v227, v[72:75] offset:2048
    ds_write_b128 v227, v[76:79] offset:3072
    v_exp_f32 v121, v121
    v_exp_f32 v122, v122
    v_exp_f32 v123, v123
    v_exp_f32 v124, v124
    v_exp_f32 v125, v125
    v_exp_f32 v126, v126
    v_exp_f32 v127, v127
    v_mfma_f32_32x32x16_bf16 v[144:159], v[208:211], v[24:27], 0
    v_mov_b32 v225, 160768
    v_mov_b32 v226, 1
    v_add_u32 v227, s11, v250
    v_exp_f32 v128, v128
    v_exp_f32 v129, v129
    v_exp_f32 v130, v130
    v_mfma_f32_32x32x16_bf16 v[144:159], v[212:215], v[28:31], v[144:159]
    v_exp_f32 v131, v131
    v_exp_f32 v132, v132
    v_exp_f32 v133, v133
    v_smfmac_f32_32x32x32_bf16 v[80:95], v[184:187], v[112:119], v224
    s_waitcnt lgkmcnt(0)
    v_exp_f32 v134, v134
    v_exp_f32 v135, v135
    v_exp_f32 v136, v136
    v_smfmac_f32_32x32x32_bf16 v[80:95], v[188:191], v[120:127], v224
    s_mov_b64 exec, 1
    ds_add_u32 v225, v226
    s_mov_b64 exec, -1
    v_exp_f32 v137, v137
    v_exp_f32 v138, v138
    v_exp_f32 v139, v139
    v_exp_f32 v140, v140
    v_exp_f32 v141, v141
    v_exp_f32 v142, v142
    v_exp_f32 v143, v143
    v_exp_f32 v144, v144
    v_exp_f32 v145, v145
    v_exp_f32 v146, v146
    v_exp_f32 v147, v147
    v_exp_f32 v148, v148
    v_exp_f32 v149, v149
    v_smfmac_f32_32x32x32_bf16 v[80:95], v[200:203], v[128:135], v224
    v_exp_f32 v150, v150
    v_exp_f32 v151, v151
    v_exp_f32 v152, v152
    v_smfmac_f32_32x32x32_bf16 v[80:95], v[204:207], v[136:143], v224
    ds_read_b32 v226, v225
    v_exp_f32 v153, v153
    v_exp_f32 v154, v154
    v_exp_f32 v155, v155
    v_exp_f32 v156, v156
    v_exp_f32 v157, v157
    v_exp_f32 v158, v158
    v_exp_f32 v159, v159
    s_waitcnt lgkmcnt(0)
    v_readfirstlane_b32 s11, v226
    v_smfmac_f32_32x32x32_bf16 v[80:95], v[216:219], v[144:151], v224
    s_cmp_lt_u32 s11, 4
    s_cbranch_scc1 Lasync
Lasync_done:
    ds_read_b128 v[96:99], v227 offset:0
    ds_read_b128 v[100:103], v227 offset:1024
    ds_read_b128 v[104:107], v227 offset:2048
    ds_read_b128 v[108:111], v227 offset:3072
    ds_read_b128 v[112:115], v227 offset:4096
    ds_read_b128 v[116:119], v227 offset:5120
    ds_read_b128 v[120:123], v227 offset:6144
    ds_read_b128 v[124:127], v227 offset:7168
    ds_read_b128 v[128:131], v227 offset:8192
    ds_read_b128 v[132:135], v227 offset:9216
    ds_read_b128 v[136:139], v227 offset:10240
    ds_read_b128 v[140:143], v227 offset:11264
    v_smfmac_f32_32x32x32_bf16 v[80:95], v[220:223], v[152:159], v224
    s_lshl_b32 s11, s7, 2
    s_add_u32 s11, s11, s3
    s_lshl_b32 s12, s11, 4
    s_add_u32 s12, s12, s6
    s_lshl_b32 s13, s12, 11
    s_add_u32 s75, s13, 0xd00000
    s_waitcnt lgkmcnt(4)
    v_add_f32 v96, v96, v112
    v_add_f32 v97, v97, v113
    v_add_f32 v98, v98, v114
    v_add_f32 v99, v99, v115
    v_add_f32 v100, v100, v116
    v_add_f32 v101, v101, v117
    v_add_f32 v102, v102, v118
    v_add_f32 v103, v103, v119
    v_add_f32 v104, v104, v120
    v_add_f32 v105, v105, v121
    v_add_f32 v106, v106, v122
    v_add_f32 v107, v107, v123
    v_add_f32 v108, v108, v124
    v_add_f32 v109, v109, v125
    v_add_f32 v110, v110, v126
    v_add_f32 v111, v111, v127
    s_waitcnt lgkmcnt(0)
    v_add_f32 v96, v96, v128
    v_add_f32 v97, v97, v129
    v_add_f32 v98, v98, v130
    v_add_f32 v99, v99, v131
    v_add_f32 v100, v100, v132
    v_add_f32 v101, v101, v133
    v_add_f32 v102, v102, v134
    v_add_f32 v103, v103, v135
    v_add_f32 v104, v104, v136
    v_add_f32 v105, v105, v137
    v_add_f32 v106, v106, v138
    v_add_f32 v107, v107, v139
    v_add_f32 v108, v108, v140
    v_add_f32 v109, v109, v141
    v_add_f32 v110, v110, v142
    v_add_f32 v111, v111, v143
    v_add_f32 v80, v80, v96
    v_add_f32 v81, v81, v97
    v_add_f32 v82, v82, v98
    v_add_f32 v83, v83, v99
    v_add_f32 v84, v84, v100
    v_add_f32 v85, v85, v101
    v_add_f32 v86, v86, v102
    v_add_f32 v87, v87, v103
    v_add_f32 v88, v88, v104
    v_add_f32 v89, v89, v105
    v_add_f32 v90, v90, v106
    v_add_f32 v91, v91, v107
    v_add_f32 v92, v92, v108
    v_add_f32 v93, v93, v109
    v_add_f32 v94, v94, v110
    v_add_f32 v95, v95, v111
    v_mul_f32 v228, 0, v80
    v_mul_f32 v229, 0, v81
    v_mul_f32 v232, 0, v82
    v_mul_f32 v233, 0, v83
    v_fma_f32 v228, v84, 0, v228
    v_fma_f32 v229, v85, 0, v229
    v_fma_f32 v232, v86, 0, v232
    v_fma_f32 v233, v87, 0, v233
    v_fma_f32 v228, v88, 0, v228
    v_fma_f32 v229, v89, 0, v229
    v_fma_f32 v232, v90, 0, v232
    v_fma_f32 v233, v91, 0, v233
    v_fma_f32 v228, v92, 0, v228
    v_fma_f32 v229, v93, 0, v229
    v_fma_f32 v232, v94, 0, v232
    v_fma_f32 v233, v95, 0, v233
    v_subrev_u32 v226, 0x2b800000, v95
    v_add_f32 v228, v228, v232
    v_add_f32 v229, v229, v233
    v_cmp_lt_u32 vcc, 0x28000000, v226
    v_cmp_u_f32 s[98:99], v228, v229
    s_and_b64 vcc, vcc, s[90:91]
    s_or_b64 vcc, vcc, s[98:99]
    s_cbranch_vccnz Lfallback
Lnormalize:
    v_rcp_f32 v225, v95
    v_lshlrev_b32 v226, 16, v30
    v_mul_f32 v226, v225, v226
    v_mov_b32 v228, v226
    s_nop 1
    v_permlane32_swap_b32 v226, v228
    v_mov_b32 v232, s10
    v_mov_b32 v233, 0xffff
    v_mul_f32 v80, v80, v228
    v_mul_f32 v81, v81, v228
    v_mul_f32 v82, v82, v228
    v_mul_f32 v83, v83, v228
    v_mul_f32 v84, v84, v228
    v_mul_f32 v85, v85, v228
    v_mul_f32 v86, v86, v228
    v_mul_f32 v87, v87, v228
    v_mul_f32 v88, v88, v228
    v_mul_f32 v89, v89, v228
    v_mul_f32 v90, v90, v228
    v_mul_f32 v91, v91, v228
    v_mul_f32 v92, v92, v228
    v_mul_f32 v93, v93, v228
    v_mul_f32 v94, v94, v228
    v_mul_f32 v95, v95, v228
    v_cvt_pk_bf16_f32 v96, v80, v81
    v_cvt_pk_bf16_f32 v97, v82, v83
    v_cvt_pk_bf16_f32 v98, v84, v85
    v_cvt_pk_bf16_f32 v99, v86, v87
    v_cvt_pk_bf16_f32 v100, v88, v89
    v_cvt_pk_bf16_f32 v101, v90, v91
    v_cvt_pk_bf16_f32 v102, v92, v93
    v_cvt_pk_bf16_f32 v103, v94, v95
    v_bfi_b32 v99, v233, v99, v232
    v_bfi_b32 v103, v233, v103, v232
    buffer_store_dwordx4 v[96:99], v250, s[52:55], s75 offen sc1
    buffer_store_dwordx4 v[100:103], v250, s[52:55], s75 offen offset:1024 sc1
    s_cmp_eq_u32 s88, 0
    s_cbranch_scc1 Lexit
    s_mov_b32 s86, 1
    s_branch Ltail
Lasync:
    s_mov_b32 s89, 67108864
Lasync_again:
    ds_read_b32 v226, v225
    s_waitcnt lgkmcnt(0)
    v_readfirstlane_b32 s11, v226
    s_sub_u32 s89, s89, 1
    s_cbranch_scc1 Lasync_done
    s_cmp_lt_u32 s11, 4
    s_cbranch_scc1 Lasync_again
    s_branch Lasync_done
Lswitch:
    v_xor_b32 v231, 0x20000, v231
    s_mov_b32 s89, 1048576
Lswitch_chk:
    v_cmp_ne_u32 vcc, s10, v244
    s_nop 0
    s_and_b32 s12, vcc_lo, s84
    s_cbranch_scc0 Lswitched
    s_sub_u32 s89, s89, 1
    s_cbranch_scc1 Lswitched
    buffer_load_dword v244, v243, s[52:55], 0 offen sc1
    s_waitcnt vmcnt(0)
    s_branch Lswitch_chk
Lfallback:
    s_lshl_b32 s73, s6, 18
    v_mov_b32 v225, 0xff800000
    s_mov_b32 s72, 0
Lfb1:
    buffer_load_dwordx4 v[160:163], v250, s[52:55], s73 offen offset:0 sc1
    buffer_load_dwordx4 v[164:167], v250, s[52:55], s73 offen offset:1024 sc1
    s_waitcnt vmcnt(0)
    v_mfma_f32_32x32x16_bf16 v[144:159], v[160:163], v[24:27], 0
    v_mfma_f32_32x32x16_bf16 v[144:159], v[164:167], v[28:31], v[144:159]
    s_nop 11
    v_max3_f32 v225, v144, v145, v225
    v_max3_f32 v225, v146, v147, v225
    v_max3_f32 v225, v148, v149, v225
    v_max3_f32 v225, v150, v151, v225
    v_max3_f32 v225, v152, v153, v225
    v_max3_f32 v225, v154, v155, v225
    v_max3_f32 v225, v156, v157, v225
    v_max3_f32 v225, v158, v159, v225
    s_add_u32 s73, s73, 4096
    s_add_u32 s72, s72, 1
    s_cmp_lt_u32 s72, 64
    s_cbranch_scc1 Lfb1
    v_mov_b32 v226, v225
    s_nop 1
    v_permlane32_swap_b32 v225, v226
    s_nop 1
    v_max_f32 v225, v225, v226
    v_mov_b32 v80, 0
    v_mov_b32 v81, 0
    v_mov_b32 v82, 0
    v_mov_b32 v83, 0
    v_mov_b32 v84, 0
    v_mov_b32 v85, 0
    v_mov_b32 v86, 0
    v_mov_b32 v87, 0
    v_mov_b32 v88, 0
    v_mov_b32 v89, 0
    v_mov_b32 v90, 0
    v_mov_b32 v91, 0
    v_mov_b32 v92, 0
    v_mov_b32 v93, 0
    v_mov_b32 v94, 0
    v_mov_b32 v95, 0
    s_lshl_b32 s73, s6, 18
    s_mov_b32 s72, 0
Lfb2:
    buffer_load_dwordx4 v[160:163], v250, s[52:55], s73 offen offset:0 sc1
    buffer_load_dwordx4 v[164:167], v250, s[52:55], s73 offen offset:1024 sc1
    buffer_load_dwordx4 v[168:171], v250, s[52:55], s73 offen offset:2048 sc1
    buffer_load_dwordx4 v[172:175], v250, s[52:55], s73 offen offset:3072 sc1
    s_waitcnt vmcnt(0)
    v_mfma_f32_32x32x16_bf16 v[144:159], v[160:163], v[24:27], 0
    v_mfma_f32_32x32x16_bf16 v[144:159], v[164:167], v[28:31], v[144:159]
    s_nop 11
    v_sub_f32 v144, v144, v225
    v_sub_f32 v145, v145, v225
    v_sub_f32 v146, v146, v225
    v_sub_f32 v147, v147, v225
    v_sub_f32 v148, v148, v225
    v_sub_f32 v149, v149, v225
    v_sub_f32 v150, v150, v225
    v_sub_f32 v151, v151, v225
    v_sub_f32 v152, v152, v225
    v_sub_f32 v153, v153, v225
    v_sub_f32 v154, v154, v225
    v_sub_f32 v155, v155, v225
    v_sub_f32 v156, v156, v225
    v_sub_f32 v157, v157, v225
    v_sub_f32 v158, v158, v225
    v_sub_f32 v159, v159, v225
    v_exp_f32 v144, v144
    v_exp_f32 v145, v145
    v_exp_f32 v146, v146
    v_exp_f32 v147, v147
    v_exp_f32 v148, v148
    v_exp_f32 v149, v149
    v_exp_f32 v150, v150
    v_exp_f32 v151, v151
    v_exp_f32 v152, v152
    v_exp_f32 v153, v153
    v_exp_f32 v154, v154
    v_exp_f32 v155, v155
    v_exp_f32 v156, v156
    v_exp_f32 v157, v157
    v_exp_f32 v158, v158
    v_exp_f32 v159, v159
    s_nop 1
    v_smfmac_f32_32x32x32_bf16 v[80:95], v[168:171], v[144:151], v224
    v_smfmac_f32_32x32x32_bf16 v[80:95], v[172:175], v[152:159], v224
    s_add_u32 s73, s73, 4096
    s_add_u32 s72, s72, 1
    s_cmp_lt_u32 s72, 64
    s_cbranch_scc1 Lfb2
    s_nop 11
    s_branch Lnormalize
Ldown:
    s_mov_b32 s86, 0
    s_setprio 3
    s_and_b32 s12, s3, 3
    s_lshl_b32 s11, s8, 1
    s_add_u32 s14, s11, s86
    s_lshl_b32 s11, s14, 2
    s_add_u32 s11, s11, s12
    s_lshl_b32 s13, s11, 13
    s_add_u32 s76, s13, 0xd00000
    s_add_u32 s78, s76, 4096
    s_mul_i32 s13, s12, 26624
    s_add_u32 s13, s13, 53248
    v_bfe_u32 v240, v251, 2, 2
    v_lshrrev_b32 v241, 5, v251
    v_mad_u32_u24 v240, v241, 7, v240
    v_lshl_add_u32 v241, v240, 7, s13
    v_bfe_u32 v240, v240, 1, 1
    v_lshlrev_b32 v240, 6, v240
    v_bfe_u32 v242, v251, 4, 1
    v_add_u32 v242, s12, v242
    v_and_b32 v243, 3, v251
    v_lshlrev_b32 v243, 3, v243
    v_add_u32 v239, 0, v242
    v_and_b32 v239, 3, v239
    v_lshl_add_u32 v239, v239, 5, v243
    v_xor_b32 v239, v239, v240
    v_add_u32 v244, v239, v241
    v_xor_b32 v239, 64, v239
    v_add_u32 v246, v239, v241
    v_add_u32 v239, 2, v242
    v_and_b32 v239, 3, v239
    v_lshl_add_u32 v239, v239, 5, v243
    v_xor_b32 v239, v239, v240
    v_add_u32 v245, v239, v241
    v_xor_b32 v239, 64, v239
    v_add_u32 v247, v239, v241
    s_mov_b32 s64, s32
    s_mov_b32 s65, s33
    s_mov_b32 s66, 0x1c0000
    s_mov_b32 s67, 0x20000
    v_and_b32 v240, 31, v251
    s_lshl_b32 s14, s14, 5
    v_add_u32 v240, s14, v240
    v_mul_u32_u24 v240, 896, v240
    v_lshrrev_b32 v243, 5, v251
    v_lshlrev_b32 v243, 4, v243
    s_lshl_b32 s13, s9, 7
    s_lshl_b32 s14, s12, 5
    s_add_u32 s13, s13, s14
    v_add3_u32 v249, v240, v243, s13
    s_mul_i32 s15, s86, 24576
    s_add_u32 s11, s12, 1
    s_and_b32 s11, s11, 3
    s_mul_i32 s11, s11, 6144
    s_add_u32 s11, s11, s15
    s_add_u32 s11, s11, 0
    v_add_u32 v233, s11, v250
    s_add_u32 s11, s12, 2
    s_and_b32 s11, s11, 3
    s_mul_i32 s11, s11, 6144
    s_add_u32 s11, s11, s15
    s_add_u32 s11, s11, 2048
    v_add_u32 v234, s11, v250
    s_add_u32 s11, s12, 3
    s_and_b32 s11, s11, 3
    s_mul_i32 s11, s11, 6144
    s_add_u32 s11, s11, s15
    s_add_u32 s11, s11, 4096
    v_add_u32 v235, s11, v250
    s_mul_i32 s11, s12, 6144
    s_add_u32 s11, s11, s15
    v_add_u32 v232, s11, v250
    s_and_b32 s15, s10, 0xffff0000
    s_setprio 0
    s_mov_b32 s89, 1048576
Lpoll_21:
    buffer_load_dword v242, v248, s[52:55], 0 offen sc1
    s_waitcnt vmcnt(0)
    v_cmp_ne_u32 vcc, s10, v242
    s_nop 1
    s_cbranch_vccz Lpdone_22
    s_sub_u32 s89, s89, 1
    s_cbranch_scc1 Lpdone_22
    s_sleep 1
    s_branch Lpoll_21
Lpdone_22:
    s_setprio 0
    buffer_load_dwordx4 v[64:67], v225, s[52:55], s73 offen sc1
    buffer_load_dwordx4 v[68:71], v229, s[52:55], s73 offen sc1
    s_add_u32 s73, s73, 1024
    s_cmp_eq_u32 s73, 28672
    s_cselect_b32 s73, 0, s73
    buffer_load_dwordx4 v[72:75], v225, s[52:55], s73 offen sc1
    buffer_load_dwordx4 v[76:79], v229, s[52:55], s73 offen sc1
    s_add_u32 s73, s73, 1024
    s_cmp_eq_u32 s73, 28672
    s_cselect_b32 s73, 0, s73
    buffer_load_dwordx4 v[80:83], v225, s[52:55], s73 offen sc1
    buffer_load_dwordx4 v[84:87], v229, s[52:55], s73 offen sc1
    s_add_u32 s73, s73, 1024
    s_cmp_eq_u32 s73, 28672
    s_cselect_b32 s73, 0, s73
    buffer_load_dwordx4 v[88:91], v225, s[52:55], s73 offen sc1
    buffer_load_dwordx4 v[92:95], v229, s[52:55], s73 offen sc1
    s_add_u32 s73, s73, 1024
    s_cmp_eq_u32 s73, 28672
    s_cselect_b32 s73, 0, s73
    buffer_load_dwordx4 v[96:99], v225, s[52:55], s73 offen sc1
    buffer_load_dwordx4 v[100:103], v229, s[52:55], s73 offen sc1
    s_add_u32 s73, s73, 1024
    s_cmp_eq_u32 s73, 28672
    s_cselect_b32 s73, 0, s73
    buffer_load_dwordx4 v[104:107], v225, s[52:55], s73 offen sc1
    buffer_load_dwordx4 v[108:111], v229, s[52:55], s73 offen sc1
    s_add_u32 s73, s73, 1024
    s_cmp_eq_u32 s73, 28672
    s_cselect_b32 s73, 0, s73
    buffer_load_dwordx4 v[112:115], v225, s[52:55], s73 offen sc1
    buffer_load_dwordx4 v[116:119], v229, s[52:55], s73 offen sc1
    s_add_u32 s73, s73, 1024
    s_cmp_eq_u32 s73, 28672
    s_cselect_b32 s73, 0, s73
    ds_read_b64_tr_b16 v[128:129], v227 offset:0
    ds_read_b64_tr_b16 v[130:131], v227 offset:1024
    ds_read_b64_tr_b16 v[132:133], v228 offset:0
    ds_read_b64_tr_b16 v[134:135], v228 offset:1024
    s_waitcnt vmcnt(12) lgkmcnt(0)
    ds_read_b64_tr_b16 v[136:137], v227 offset:2048
    ds_read_b64_tr_b16 v[138:139], v227 offset:3072
    ds_read_b64_tr_b16 v[140:141], v228 offset:2048
    ds_read_b64_tr_b16 v[142:143], v228 offset:3072
    v_mfma_f32_32x32x16_bf16 v[0:15], v[128:131], v[64:67], 0
    buffer_load_dwordx4 v[120:123], v225, s[52:55], s73 offen sc1
    v_mfma_f32_32x32x16_bf16 v[16:31], v[132:135], v[64:67], 0
    buffer_load_dwordx4 v[124:127], v229, s[52:55], s73 offen sc1
    s_add_u32 s73, s73, 1024
    s_cmp_eq_u32 s73, 28672
    s_cselect_b32 s73, 0, s73
    v_mfma_f32_32x32x16_bf16 v[32:47], v[128:131], v[68:71], 0
    s_add_u32 m0, s1, 0
    s_nop 0
    buffer_load_dwordx4 v226, s[56:59], s0 offen lds
    s_add_u32 s0, s0, 7168
    v_mfma_f32_32x32x16_bf16 v[48:63], v[132:135], v[68:71], 0
    s_add_u32 m0, s1, 1024
    s_nop 0
    buffer_load_dwordx4 v226, s[56:59], s0 offen lds
    s_add_u32 s0, s0, 7168
    s_cmp_eq_u32 s0, s77
    s_cselect_b32 s0, s22, s0
    s_waitcnt vmcnt(14) lgkmcnt(0)
    ds_read_b64_tr_b16 v[128:129], v227 offset:4096
    ds_read_b64_tr_b16 v[130:131], v227 offset:5120
    ds_read_b64_tr_b16 v[132:133], v228 offset:4096
    ds_read_b64_tr_b16 v[134:135], v228 offset:5120
    v_mfma_f32_32x32x16_bf16 v[0:15], v[136:139], v[72:75], v[0:15]
    buffer_load_dwordx4 v[64:67], v225, s[52:55], s73 offen sc1
    v_mfma_f32_32x32x16_bf16 v[16:31], v[140:143], v[72:75], v[16:31]
    buffer_load_dwordx4 v[68:71], v229, s[52:55], s73 offen sc1
    s_add_u32 s73, s73, 1024
    s_cmp_eq_u32 s73, 28672
    s_cselect_b32 s73, 0, s73
    v_mfma_f32_32x32x16_bf16 v[32:47], v[136:139], v[76:79], v[32:47]
    s_add_u32 m0, s1, 2048
    s_nop 0
    buffer_load_dwordx4 v226, s[56:59], s0 offen lds
    s_add_u32 s0, s0, 7168
    v_mfma_f32_32x32x16_bf16 v[48:63], v[140:143], v[76:79], v[48:63]
    s_add_u32 m0, s1, 3072
    s_nop 0
    buffer_load_dwordx4 v226, s[56:59], s0 offen lds
    s_add_u32 s0, s0, 7168
    s_cmp_eq_u32 s0, s77
    s_cselect_b32 s0, s22, s0
    s_waitcnt vmcnt(16) lgkmcnt(0)
    ds_read_b64_tr_b16 v[136:137], v227 offset:6144
    ds_read_b64_tr_b16 v[138:139], v227 offset:7168
    ds_read_b64_tr_b16 v[140:141], v228 offset:6144
    ds_read_b64_tr_b16 v[142:143], v228 offset:7168
    v_mfma_f32_32x32x16_bf16 v[0:15], v[128:131], v[80:83], v[0:15]
    buffer_load_dwordx4 v[72:75], v225, s[52:55], s73 offen sc1
    v_mfma_f32_32x32x16_bf16 v[16:31], v[132:135], v[80:83], v[16:31]
    buffer_load_dwordx4 v[76:79], v229, s[52:55], s73 offen sc1
    s_add_u32 s73, s73, 1024
    s_cmp_eq_u32 s73, 28672
    s_cselect_b32 s73, 0, s73
    v_mfma_f32_32x32x16_bf16 v[32:47], v[128:131], v[84:87], v[32:47]
    s_add_u32 m0, s1, 4096
    s_nop 0
    buffer_load_dwordx4 v226, s[56:59], s0 offen lds
    s_add_u32 s0, s0, 7168
    v_mfma_f32_32x32x16_bf16 v[48:63], v[132:135], v[84:87], v[48:63]
    s_add_u32 m0, s1, 5120
    s_nop 0
    buffer_load_dwordx4 v226, s[56:59], s0 offen lds
    s_add_u32 s0, s0, 7168
    s_cmp_eq_u32 s0, s77
    s_cselect_b32 s0, s22, s0
    s_waitcnt vmcnt(18) lgkmcnt(0)
    ds_read_b64_tr_b16 v[128:129], v227 offset:8192
    ds_read_b64_tr_b16 v[130:131], v227 offset:9216
    ds_read_b64_tr_b16 v[132:133], v228 offset:8192
    ds_read_b64_tr_b16 v[134:135], v228 offset:9216
    v_mfma_f32_32x32x16_bf16 v[0:15], v[136:139], v[88:91], v[0:15]
    buffer_load_dwordx4 v[80:83], v225, s[52:55], s73 offen sc1
    v_mfma_f32_32x32x16_bf16 v[16:31], v[140:143], v[88:91], v[16:31]
    buffer_load_dwordx4 v[84:87], v229, s[52:55], s73 offen sc1
    s_add_u32 s73, s73, 1024
    s_cmp_eq_u32 s73, 28672
    s_cselect_b32 s73, 0, s73
    v_mfma_f32_32x32x16_bf16 v[32:47], v[136:139], v[92:95], v[32:47]
    s_add_u32 m0, s1, 6144
    s_nop 0
    buffer_load_dwordx4 v226, s[56:59], s0 offen lds
    s_add_u32 s0, s0, 7168
    v_mfma_f32_32x32x16_bf16 v[48:63], v[140:143], v[92:95], v[48:63]
    s_add_u32 m0, s1, 7168
    s_nop 0
    buffer_load_dwordx4 v226, s[56:59], s0 offen lds
    s_add_u32 s0, s0, 7168
    s_cmp_eq_u32 s0, s77
    s_cselect_b32 s0, s22, s0
    s_waitcnt vmcnt(20) lgkmcnt(0)
    ds_read_b64_tr_b16 v[136:137], v227 offset:10240
    ds_read_b64_tr_b16 v[138:139], v227 offset:11264
    ds_read_b64_tr_b16 v[140:141], v228 offset:10240
    ds_read_b64_tr_b16 v[142:143], v228 offset:11264
    v_mfma_f32_32x32x16_bf16 v[0:15], v[128:131], v[96:99], v[0:15]
    buffer_load_dwordx4 v[88:91], v225, s[52:55], s73 offen sc1
    v_mfma_f32_32x32x16_bf16 v[16:31], v[132:135], v[96:99], v[16:31]
    buffer_load_dwordx4 v[92:95], v229, s[52:55], s73 offen sc1
    s_add_u32 s73, s73, 1024
    s_cmp_eq_u32 s73, 28672
    s_cselect_b32 s73, 0, s73
    v_mfma_f32_32x32x16_bf16 v[32:47], v[128:131], v[100:103], v[32:47]
    s_add_u32 m0, s1, 8192
    s_nop 0
    buffer_load_dwordx4 v226, s[56:59], s0 offen lds
    s_add_u32 s0, s0, 7168
    v_mfma_f32_32x32x16_bf16 v[48:63], v[132:135], v[100:103], v[48:63]
    s_add_u32 m0, s1, 9216
    s_nop 0
    buffer_load_dwordx4 v226, s[56:59], s0 offen lds
    s_add_u32 s0, s0, 7168
    s_cmp_eq_u32 s0, s77
    s_cselect_b32 s0, s22, s0
    s_waitcnt vmcnt(22) lgkmcnt(0)
    ds_read_b64_tr_b16 v[128:129], v227 offset:12288
    ds_read_b64_tr_b16 v[130:131], v227 offset:13312
    ds_read_b64_tr_b16 v[132:133], v228 offset:12288
    ds_read_b64_tr_b16 v[134:135], v228 offset:13312
    v_mfma_f32_32x32x16_bf16 v[0:15], v[136:139], v[104:107], v[0:15]
    buffer_load_dwordx4 v[96:99], v225, s[52:55], s73 offen sc1
    v_mfma_f32_32x32x16_bf16 v[16:31], v[140:143], v[104:107], v[16:31]
    buffer_load_dwordx4 v[100:103], v229, s[52:55], s73 offen sc1
    s_add_u32 s73, s73, 1024
    s_cmp_eq_u32 s73, 28672
    s_cselect_b32 s73, 0, s73
    v_mfma_f32_32x32x16_bf16 v[32:47], v[136:139], v[108:111], v[32:47]
    s_add_u32 m0, s1, 10240
    s_nop 0
    buffer_load_dwordx4 v226, s[56:59], s0 offen lds
    s_add_u32 s0, s0, 7168
    v_mfma_f32_32x32x16_bf16 v[48:63], v[140:143], v[108:111], v[48:63]
    s_add_u32 m0, s1, 11264
    s_nop 0
    buffer_load_dwordx4 v226, s[56:59], s0 offen lds
    s_add_u32 s0, s0, 7168
    s_cmp_eq_u32 s0, s77
    s_cselect_b32 s0, s22, s0
    s_waitcnt vmcnt(24) lgkmcnt(0)
    ds_read_b64_tr_b16 v[136:137], v227 offset:14336
    ds_read_b64_tr_b16 v[138:139], v227 offset:15360
    ds_read_b64_tr_b16 v[140:141], v228 offset:14336
    ds_read_b64_tr_b16 v[142:143], v228 offset:15360
    v_mfma_f32_32x32x16_bf16 v[0:15], v[128:131], v[112:115], v[0:15]
    buffer_load_dwordx4 v[104:107], v225, s[52:55], s73 offen sc1
    v_mfma_f32_32x32x16_bf16 v[16:31], v[132:135], v[112:115], v[16:31]
    buffer_load_dwordx4 v[108:111], v229, s[52:55], s73 offen sc1
    s_add_u32 s73, s73, 1024
    s_cmp_eq_u32 s73, 28672
    s_cselect_b32 s73, 0, s73
    v_mfma_f32_32x32x16_bf16 v[32:47], v[128:131], v[116:119], v[32:47]
    s_add_u32 m0, s1, 12288
    s_nop 0
    buffer_load_dwordx4 v226, s[56:59], s0 offen lds
    s_add_u32 s0, s0, 7168
    v_mfma_f32_32x32x16_bf16 v[48:63], v[132:135], v[116:119], v[48:63]
    s_add_u32 m0, s1, 13312
    s_nop 0
    buffer_load_dwordx4 v226, s[56:59], s0 offen lds
    s_add_u32 s0, s0, 7168
    s_cmp_eq_u32 s0, s77
    s_cselect_b32 s0, s22, s0
    s_waitcnt vmcnt(26) lgkmcnt(0)
    ds_read_b64_tr_b16 v[128:129], v227 offset:16384
    ds_read_b64_tr_b16 v[130:131], v227 offset:17408
    ds_read_b64_tr_b16 v[132:133], v228 offset:16384
    ds_read_b64_tr_b16 v[134:135], v228 offset:17408
    v_mfma_f32_32x32x16_bf16 v[0:15], v[136:139], v[120:123], v[0:15]
    buffer_load_dwordx4 v[112:115], v225, s[52:55], s73 offen sc1
    v_mfma_f32_32x32x16_bf16 v[16:31], v[140:143], v[120:123], v[16:31]
    buffer_load_dwordx4 v[116:119], v229, s[52:55], s73 offen sc1
    s_add_u32 s73, s73, 1024
    s_cmp_eq_u32 s73, 28672
    s_cselect_b32 s73, 0, s73
    v_mfma_f32_32x32x16_bf16 v[32:47], v[136:139], v[124:127], v[32:47]
    s_add_u32 m0, s1, 14336
    s_nop 0
    buffer_load_dwordx4 v226, s[56:59], s0 offen lds
    s_add_u32 s0, s0, 7168
    v_mfma_f32_32x32x16_bf16 v[48:63], v[140:143], v[124:127], v[48:63]
    s_add_u32 m0, s1, 15360
    s_nop 0
    buffer_load_dwordx4 v226, s[56:59], s0 offen lds
    s_add_u32 s0, s0, 7168
    s_cmp_eq_u32 s0, s77
    s_cselect_b32 s0, s22, s0
    s_waitcnt vmcnt(26) lgkmcnt(0)
    ds_read_b64_tr_b16 v[136:137], v227 offset:18432
    ds_read_b64_tr_b16 v[138:139], v227 offset:19456
    ds_read_b64_tr_b16 v[140:141], v228 offset:18432
    ds_read_b64_tr_b16 v[142:143], v228 offset:19456
    v_mfma_f32_32x32x16_bf16 v[0:15], v[128:131], v[64:67], v[0:15]
    buffer_load_dwordx4 v[120:123], v225, s[52:55], s73 offen sc1
    v_mfma_f32_32x32x16_bf16 v[16:31], v[132:135], v[64:67], v[16:31]
    buffer_load_dwordx4 v[124:127], v229, s[52:55], s73 offen sc1
    s_add_u32 s73, s73, 1024
    s_cmp_eq_u32 s73, 28672
    s_cselect_b32 s73, 0, s73
    v_mfma_f32_32x32x16_bf16 v[32:47], v[128:131], v[68:71], v[32:47]
    s_add_u32 m0, s1, 16384
    s_nop 0
    buffer_load_dwordx4 v226, s[56:59], s0 offen lds
    s_add_u32 s0, s0, 7168
    v_mfma_f32_32x32x16_bf16 v[48:63], v[132:135], v[68:71], v[48:63]
    s_add_u32 m0, s1, 17408
    s_nop 0
    buffer_load_dwordx4 v226, s[56:59], s0 offen lds
    s_add_u32 s0, s0, 7168
    s_cmp_eq_u32 s0, s77
    s_cselect_b32 s0, s22, s0
    s_waitcnt vmcnt(26) lgkmcnt(0)
    ds_read_b64_tr_b16 v[128:129], v227 offset:20480
    ds_read_b64_tr_b16 v[130:131], v227 offset:21504
    ds_read_b64_tr_b16 v[132:133], v228 offset:20480
    ds_read_b64_tr_b16 v[134:135], v228 offset:21504
    v_mfma_f32_32x32x16_bf16 v[0:15], v[136:139], v[72:75], v[0:15]
    buffer_load_dwordx4 v[64:67], v225, s[52:55], s73 offen sc1
    v_mfma_f32_32x32x16_bf16 v[16:31], v[140:143], v[72:75], v[16:31]
    buffer_load_dwordx4 v[68:71], v229, s[52:55], s73 offen sc1
    s_add_u32 s73, s73, 1024
    s_cmp_eq_u32 s73, 28672
    s_cselect_b32 s73, 0, s73
    v_mfma_f32_32x32x16_bf16 v[32:47], v[136:139], v[76:79], v[32:47]
    s_add_u32 m0, s1, 18432
    s_nop 0
    buffer_load_dwordx4 v226, s[56:59], s0 offen lds
    s_add_u32 s0, s0, 7168
    v_mfma_f32_32x32x16_bf16 v[48:63], v[140:143], v[76:79], v[48:63]
    s_add_u32 m0, s1, 19456
    s_nop 0
    buffer_load_dwordx4 v226, s[56:59], s0 offen lds
    s_add_u32 s0, s0, 7168
    s_cmp_eq_u32 s0, s77
    s_cselect_b32 s0, s22, s0
    s_waitcnt vmcnt(26) lgkmcnt(0)
    ds_read_b64_tr_b16 v[136:137], v227 offset:22528
    ds_read_b64_tr_b16 v[138:139], v227 offset:23552
    ds_read_b64_tr_b16 v[140:141], v228 offset:22528
    ds_read_b64_tr_b16 v[142:143], v228 offset:23552
    v_mfma_f32_32x32x16_bf16 v[0:15], v[128:131], v[80:83], v[0:15]
    buffer_load_dwordx4 v[72:75], v225, s[52:55], s73 offen sc1
    v_mfma_f32_32x32x16_bf16 v[16:31], v[132:135], v[80:83], v[16:31]
    buffer_load_dwordx4 v[76:79], v229, s[52:55], s73 offen sc1
    s_add_u32 s73, s73, 1024
    s_cmp_eq_u32 s73, 28672
    s_cselect_b32 s73, 0, s73
    v_mfma_f32_32x32x16_bf16 v[32:47], v[128:131], v[84:87], v[32:47]
    s_add_u32 m0, s1, 20480
    s_nop 0
    buffer_load_dwordx4 v226, s[56:59], s0 offen lds
    s_add_u32 s0, s0, 7168
    v_mfma_f32_32x32x16_bf16 v[48:63], v[132:135], v[84:87], v[48:63]
    s_add_u32 m0, s1, 21504
    s_nop 0
    buffer_load_dwordx4 v226, s[56:59], s0 offen lds
    s_add_u32 s0, s0, 7168
    s_cmp_eq_u32 s0, s77
    s_cselect_b32 s0, s22, s0
    s_waitcnt vmcnt(26) lgkmcnt(0)
    ds_read_b64_tr_b16 v[128:129], v227 offset:24576
    ds_read_b64_tr_b16 v[130:131], v227 offset:25600
    ds_read_b64_tr_b16 v[132:133], v228 offset:24576
    ds_read_b64_tr_b16 v[134:135], v228 offset:25600
    v_mfma_f32_32x32x16_bf16 v[0:15], v[136:139], v[88:91], v[0:15]
    buffer_load_dwordx4 v[80:83], v225, s[52:55], s73 offen sc1
    v_mfma_f32_32x32x16_bf16 v[16:31], v[140:143], v[88:91], v[16:31]
    buffer_load_dwordx4 v[84:87], v229, s[52:55], s73 offen sc1
    s_add_u32 s73, s73, 1024
    s_cmp_eq_u32 s73, 28672
    s_cselect_b32 s73, 0, s73
    v_mfma_f32_32x32x16_bf16 v[32:47], v[136:139], v[92:95], v[32:47]
    s_add_u32 m0, s1, 22528
    s_nop 0
    buffer_load_dwordx4 v226, s[56:59], s0 offen lds
    s_add_u32 s0, s0, 7168
    v_mfma_f32_32x32x16_bf16 v[48:63], v[140:143], v[92:95], v[48:63]
    s_add_u32 m0, s1, 23552
    s_nop 0
    buffer_load_dwordx4 v226, s[56:59], s0 offen lds
    s_add_u32 s0, s0, 7168
    s_cmp_eq_u32 s0, s77
    s_cselect_b32 s0, s22, s0
    s_waitcnt vmcnt(26) lgkmcnt(0)
    ds_read_b64_tr_b16 v[136:137], v227 offset:0
    ds_read_b64_tr_b16 v[138:139], v227 offset:1024
    ds_read_b64_tr_b16 v[140:141], v228 offset:0
    ds_read_b64_tr_b16 v[142:143], v228 offset:1024
    v_mfma_f32_32x32x16_bf16 v[0:15], v[128:131], v[96:99], v[0:15]
    buffer_load_dwordx4 v[88:91], v225, s[52:55], s73 offen sc1
    v_mfma_f32_32x32x16_bf16 v[16:31], v[132:135], v[96:99], v[16:31]
    buffer_load_dwordx4 v[92:95], v229, s[52:55], s73 offen sc1
    s_add_u32 s73, s73, 1024
    s_cmp_eq_u32 s73, 28672
    s_cselect_b32 s73, 0, s73
    v_mfma_f32_32x32x16_bf16 v[32:47], v[128:131], v[100:103], v[32:47]
    s_add_u32 m0, s1, 24576
    s_nop 0
    buffer_load_dwordx4 v226, s[56:59], s0 offen lds
    s_add_u32 s0, s0, 7168
    v_mfma_f32_32x32x16_bf16 v[48:63], v[132:135], v[100:103], v[48:63]
    s_add_u32 m0, s1, 25600
    s_nop 0
    buffer_load_dwordx4 v226, s[56:59], s0 offen lds
    s_add_u32 s0, s0, 7168
    s_cmp_eq_u32 s0, s77
    s_cselect_b32 s0, s22, s0
    s_waitcnt vmcnt(26) lgkmcnt(0)
    ds_read_b64_tr_b16 v[128:129], v227 offset:2048
    ds_read_b64_tr_b16 v[130:131], v227 offset:3072
    ds_read_b64_tr_b16 v[132:133], v228 offset:2048
    ds_read_b64_tr_b16 v[134:135], v228 offset:3072
    v_mfma_f32_32x32x16_bf16 v[0:15], v[136:139], v[104:107], v[0:15]
    buffer_load_dwordx4 v[96:99], v225, s[52:55], s73 offen sc1
    v_mfma_f32_32x32x16_bf16 v[16:31], v[140:143], v[104:107], v[16:31]
    buffer_load_dwordx4 v[100:103], v229, s[52:55], s73 offen sc1
    s_add_u32 s73, s73, 1024
    s_cmp_eq_u32 s73, 28672
    s_cselect_b32 s73, 0, s73
    v_mfma_f32_32x32x16_bf16 v[32:47], v[136:139], v[108:111], v[32:47]
    s_add_u32 m0, s1, 0
    s_nop 0
    buffer_load_dwordx4 v226, s[56:59], s0 offen lds
    s_add_u32 s0, s0, 7168
    v_mfma_f32_32x32x16_bf16 v[48:63], v[140:143], v[108:111], v[48:63]
    s_add_u32 m0, s1, 1024
    s_nop 0
    buffer_load_dwordx4 v226, s[56:59], s0 offen lds
    s_add_u32 s0, s0, 7168
    s_cmp_eq_u32 s0, s77
    s_cselect_b32 s0, s22, s0
    s_waitcnt vmcnt(26) lgkmcnt(0)
    ds_read_b64_tr_b16 v[136:137], v227 offset:4096
    ds_read_b64_tr_b16 v[138:139], v227 offset:5120
    ds_read_b64_tr_b16 v[140:141], v228 offset:4096
    ds_read_b64_tr_b16 v[142:143], v228 offset:5120
    v_mfma_f32_32x32x16_bf16 v[0:15], v[128:131], v[112:115], v[0:15]
    buffer_load_dwordx4 v[104:107], v225, s[52:55], s73 offen sc1
    v_mfma_f32_32x32x16_bf16 v[16:31], v[132:135], v[112:115], v[16:31]
    buffer_load_dwordx4 v[108:111], v229, s[52:55], s73 offen sc1
    s_add_u32 s73, s73, 1024
    s_cmp_eq_u32 s73, 28672
    s_cselect_b32 s73, 0, s73
    v_mfma_f32_32x32x16_bf16 v[32:47], v[128:131], v[116:119], v[32:47]
    s_add_u32 m0, s1, 2048
    s_nop 0
    buffer_load_dwordx4 v226, s[56:59], s0 offen lds
    s_add_u32 s0, s0, 7168
    v_mfma_f32_32x32x16_bf16 v[48:63], v[132:135], v[116:119], v[48:63]
    s_add_u32 m0, s1, 3072
    s_nop 0
    buffer_load_dwordx4 v226, s[56:59], s0 offen lds
    s_add_u32 s0, s0, 7168
    s_cmp_eq_u32 s0, s77
    s_cselect_b32 s0, s22, s0
    s_waitcnt vmcnt(26) lgkmcnt(0)
    ds_read_b64_tr_b16 v[128:129], v227 offset:6144
    ds_read_b64_tr_b16 v[130:131], v227 offset:7168
    ds_read_b64_tr_b16 v[132:133], v228 offset:6144
    ds_read_b64_tr_b16 v[134:135], v228 offset:7168
    v_mfma_f32_32x32x16_bf16 v[0:15], v[136:139], v[120:123], v[0:15]
    buffer_load_dwordx4 v[112:115], v225, s[52:55], s73 offen sc1
    v_mfma_f32_32x32x16_bf16 v[16:31], v[140:143], v[120:123], v[16:31]
    buffer_load_dwordx4 v[116:119], v229, s[52:55], s73 offen sc1
    s_add_u32 s73, s73, 1024
    s_cmp_eq_u32 s73, 28672
    s_cselect_b32 s73, 0, s73
    v_mfma_f32_32x32x16_bf16 v[32:47], v[136:139], v[124:127], v[32:47]
    s_add_u32 m0, s1, 4096
    s_nop 0
    buffer_load_dwordx4 v226, s[60:63], s23 offen lds
    s_add_u32 s23, s23, 7168
    v_mfma_f32_32x32x16_bf16 v[48:63], v[140:143], v[124:127], v[48:63]
    s_add_u32 m0, s1, 5120
    s_nop 0
    buffer_load_dwordx4 v226, s[60:63], s23 offen lds
    s_add_u32 s23, s23, 7168
    s_waitcnt vmcnt(26) lgkmcnt(0)
    ds_read_b64_tr_b16 v[136:137], v227 offset:8192
    ds_read_b64_tr_b16 v[138:139], v227 offset:9216
    ds_read_b64_tr_b16 v[140:141], v228 offset:8192
    ds_read_b64_tr_b16 v[142:143], v228 offset:9216
    v_mfma_f32_32x32x16_bf16 v[0:15], v[128:131], v[64:67], v[0:15]
    buffer_load_dwordx4 v[120:123], v225, s[52:55], s73 offen sc1
    v_mfma_f32_32x32x16_bf16 v[16:31], v[132:135], v[64:67], v[16:31]
    buffer_load_dwordx4 v[124:127], v229, s[52:55], s73 offen sc1
    s_add_u32 s73, s73, 1024
    s_cmp_eq_u32 s73, 28672
    s_cselect_b32 s73, 0, s73
    v_mfma_f32_32x32x16_bf16 v[32:47], v[128:131], v[68:71], v[32:47]
    s_add_u32 m0, s1, 6144
    s_nop 0
    buffer_load_dwordx4 v226, s[60:63], s23 offen lds
    s_add_u32 s23, s23, 7168
    v_mfma_f32_32x32x16_bf16 v[48:63], v[132:135], v[68:71], v[48:63]
    s_add_u32 m0, s1, 7168
    s_nop 0
    buffer_load_dwordx4 v226, s[60:63], s23 offen lds
    s_add_u32 s23, s23, 7168
    s_waitcnt vmcnt(26) lgkmcnt(0)
    ds_read_b64_tr_b16 v[128:129], v227 offset:10240
    ds_read_b64_tr_b16 v[130:131], v227 offset:11264
    ds_read_b64_tr_b16 v[132:133], v228 offset:10240
    ds_read_b64_tr_b16 v[134:135], v228 offset:11264
    v_mfma_f32_32x32x16_bf16 v[0:15], v[136:139], v[72:75], v[0:15]
    buffer_load_dwordx4 v[64:67], v225, s[52:55], s73 offen sc1
    v_mfma_f32_32x32x16_bf16 v[16:31], v[140:143], v[72:75], v[16:31]
    buffer_load_dwordx4 v[68:71], v229, s[52:55], s73 offen sc1
    s_add_u32 s73, s73, 1024
    s_cmp_eq_u32 s73, 28672
    s_cselect_b32 s73, 0, s73
    v_mfma_f32_32x32x16_bf16 v[32:47], v[136:139], v[76:79], v[32:47]
    s_add_u32 m0, s1, 8192
    s_nop 0
    buffer_load_dwordx4 v226, s[60:63], s23 offen lds
    s_add_u32 s23, s23, 7168
    v_mfma_f32_32x32x16_bf16 v[48:63], v[140:143], v[76:79], v[48:63]
    s_add_u32 m0, s1, 9216
    s_nop 0
    buffer_load_dwordx4 v226, s[60:63], s23 offen lds
    s_add_u32 s23, s23, 7168
    s_waitcnt vmcnt(26) lgkmcnt(0)
    ds_read_b64_tr_b16 v[136:137], v227 offset:12288
    ds_read_b64_tr_b16 v[138:139], v227 offset:13312
    ds_read_b64_tr_b16 v[140:141], v228 offset:12288
    ds_read_b64_tr_b16 v[142:143], v228 offset:13312
    v_mfma_f32_32x32x16_bf16 v[0:15], v[128:131], v[80:83], v[0:15]
    buffer_load_dwordx4 v[72:75], v225, s[52:55], s73 offen sc1
    v_mfma_f32_32x32x16_bf16 v[16:31], v[132:135], v[80:83], v[16:31]
    buffer_load_dwordx4 v[76:79], v229, s[52:55], s73 offen sc1
    s_add_u32 s73, s73, 1024
    s_cmp_eq_u32 s73, 28672
    s_cselect_b32 s73, 0, s73
    v_mfma_f32_32x32x16_bf16 v[32:47], v[128:131], v[84:87], v[32:47]
    s_add_u32 m0, s1, 10240
    s_nop 0
    buffer_load_dwordx4 v226, s[60:63], s23 offen lds
    s_add_u32 s23, s23, 7168
    v_mfma_f32_32x32x16_bf16 v[48:63], v[132:135], v[84:87], v[48:63]
    s_add_u32 m0, s1, 11264
    s_nop 0
    buffer_load_dwordx4 v226, s[60:63], s23 offen lds
    s_add_u32 s23, s23, 7168
    s_waitcnt vmcnt(26) lgkmcnt(0)
    ds_read_b64_tr_b16 v[128:129], v227 offset:14336
    ds_read_b64_tr_b16 v[130:131], v227 offset:15360
    ds_read_b64_tr_b16 v[132:133], v228 offset:14336
    ds_read_b64_tr_b16 v[134:135], v228 offset:15360
    v_mfma_f32_32x32x16_bf16 v[0:15], v[136:139], v[88:91], v[0:15]
    buffer_load_dwordx4 v[80:83], v225, s[52:55], s73 offen sc1
    v_mfma_f32_32x32x16_bf16 v[16:31], v[140:143], v[88:91], v[16:31]
    buffer_load_dwordx4 v[84:87], v229, s[52:55], s73 offen sc1
    s_add_u32 s73, s73, 1024
    s_cmp_eq_u32 s73, 28672
    s_cselect_b32 s73, 0, s73
    v_mfma_f32_32x32x16_bf16 v[32:47], v[136:139], v[92:95], v[32:47]
    s_add_u32 m0, s1, 12288
    s_nop 0
    buffer_load_dwordx4 v226, s[60:63], s23 offen lds
    s_add_u32 s23, s23, 7168
    v_mfma_f32_32x32x16_bf16 v[48:63], v[140:143], v[92:95], v[48:63]
    s_add_u32 m0, s1, 13312
    s_nop 0
    buffer_load_dwordx4 v226, s[60:63], s23 offen lds
    s_add_u32 s23, s23, 7168
    s_waitcnt vmcnt(26) lgkmcnt(0)
    ds_read_b64_tr_b16 v[136:137], v227 offset:16384
    ds_read_b64_tr_b16 v[138:139], v227 offset:17408
    ds_read_b64_tr_b16 v[140:141], v228 offset:16384
    ds_read_b64_tr_b16 v[142:143], v228 offset:17408
    v_mfma_f32_32x32x16_bf16 v[0:15], v[128:131], v[96:99], v[0:15]
    buffer_load_dwordx4 v[88:91], v225, s[52:55], s73 offen sc1
    v_mfma_f32_32x32x16_bf16 v[16:31], v[132:135], v[96:99], v[16:31]
    buffer_load_dwordx4 v[92:95], v229, s[52:55], s73 offen sc1
    s_add_u32 s73, s73, 1024
    s_cmp_eq_u32 s73, 28672
    s_cselect_b32 s73, 0, s73
    v_mfma_f32_32x32x16_bf16 v[32:47], v[128:131], v[100:103], v[32:47]
    s_add_u32 m0, s1, 14336
    s_nop 0
    buffer_load_dwordx4 v226, s[60:63], s23 offen lds
    s_add_u32 s23, s23, 7168
    v_mfma_f32_32x32x16_bf16 v[48:63], v[132:135], v[100:103], v[48:63]
    s_add_u32 m0, s1, 15360
    s_nop 0
    buffer_load_dwordx4 v226, s[60:63], s23 offen lds
    s_add_u32 s23, s23, 7168
    s_waitcnt vmcnt(26) lgkmcnt(0)
    ds_read_b64_tr_b16 v[128:129], v227 offset:18432
    ds_read_b64_tr_b16 v[130:131], v227 offset:19456
    ds_read_b64_tr_b16 v[132:133], v228 offset:18432
    ds_read_b64_tr_b16 v[134:135], v228 offset:19456
    v_mfma_f32_32x32x16_bf16 v[0:15], v[136:139], v[104:107], v[0:15]
    s_add_u32 m0, s1, 16384
    s_nop 0
    buffer_load_dwordx4 v226, s[60:63], s23 offen lds
    s_add_u32 s23, s23, 7168
    v_mfma_f32_32x32x16_bf16 v[16:31], v[140:143], v[104:107], v[16:31]
    s_add_u32 m0, s1, 17408
    s_nop 0
    buffer_load_dwordx4 v226, s[60:63], s23 offen lds
    s_add_u32 s23, s23, 7168
    v_mfma_f32_32x32x16_bf16 v[32:47], v[136:139], v[108:111], v[32:47]
    v_mfma_f32_32x32x16_bf16 v[48:63], v[140:143], v[108:111], v[48:63]
    s_waitcnt vmcnt(24) lgkmcnt(0)
    ds_read_b64_tr_b16 v[136:137], v227 offset:20480
    ds_read_b64_tr_b16 v[138:139], v227 offset:21504
    ds_read_b64_tr_b16 v[140:141], v228 offset:20480
    ds_read_b64_tr_b16 v[142:143], v228 offset:21504
    v_mfma_f32_32x32x16_bf16 v[0:15], v[128:131], v[112:115], v[0:15]
    s_add_u32 m0, s1, 18432
    s_nop 0
    buffer_load_dwordx4 v226, s[60:63], s23 offen lds
    s_add_u32 s23, s23, 7168
    v_mfma_f32_32x32x16_bf16 v[16:31], v[132:135], v[112:115], v[16:31]
    s_add_u32 m0, s1, 19456
    s_nop 0
    buffer_load_dwordx4 v226, s[60:63], s23 offen lds
    s_add_u32 s23, s23, 7168
    v_mfma_f32_32x32x16_bf16 v[32:47], v[128:131], v[116:119], v[32:47]
    v_mfma_f32_32x32x16_bf16 v[48:63], v[132:135], v[116:119], v[48:63]
    s_waitcnt vmcnt(22) lgkmcnt(0)
    ds_read_b64_tr_b16 v[128:129], v227 offset:22528
    ds_read_b64_tr_b16 v[130:131], v227 offset:23552
    ds_read_b64_tr_b16 v[132:133], v228 offset:22528
    ds_read_b64_tr_b16 v[134:135], v228 offset:23552
    v_mfma_f32_32x32x16_bf16 v[0:15], v[136:139], v[120:123], v[0:15]
    v_mfma_f32_32x32x16_bf16 v[16:31], v[140:143], v[120:123], v[16:31]
    v_mfma_f32_32x32x16_bf16 v[32:47], v[136:139], v[124:127], v[32:47]
    v_mfma_f32_32x32x16_bf16 v[48:63], v[140:143], v[124:127], v[48:63]
    s_waitcnt vmcnt(18) lgkmcnt(0)
    ds_read_b64_tr_b16 v[136:137], v227 offset:24576
    ds_read_b64_tr_b16 v[138:139], v227 offset:25600
    ds_read_b64_tr_b16 v[140:141], v228 offset:24576
    ds_read_b64_tr_b16 v[142:143], v228 offset:25600
    v_mfma_f32_32x32x16_bf16 v[0:15], v[128:131], v[64:67], v[0:15]
    v_mfma_f32_32x32x16_bf16 v[16:31], v[132:135], v[64:67], v[16:31]
    v_mfma_f32_32x32x16_bf16 v[32:47], v[128:131], v[68:71], v[32:47]
    v_mfma_f32_32x32x16_bf16 v[48:63], v[132:135], v[68:71], v[48:63]
    s_waitcnt vmcnt(14) lgkmcnt(0)
    ds_read_b64_tr_b16 v[128:129], v227 offset:0
    ds_read_b64_tr_b16 v[130:131], v227 offset:1024
    ds_read_b64_tr_b16 v[132:133], v228 offset:0
    ds_read_b64_tr_b16 v[134:135], v228 offset:1024
    v_mfma_f32_32x32x16_bf16 v[0:15], v[136:139], v[72:75], v[0:15]
    v_mfma_f32_32x32x16_bf16 v[16:31], v[140:143], v[72:75], v[16:31]
    v_mfma_f32_32x32x16_bf16 v[32:47], v[136:139], v[76:79], v[32:47]
    v_mfma_f32_32x32x16_bf16 v[48:63], v[140:143], v[76:79], v[48:63]
    s_waitcnt vmcnt(10) lgkmcnt(0)
    ds_read_b64_tr_b16 v[136:137], v227 offset:2048
    ds_read_b64_tr_b16 v[138:139], v227 offset:3072
    ds_read_b64_tr_b16 v[140:141], v228 offset:2048
    ds_read_b64_tr_b16 v[142:143], v228 offset:3072
    v_mfma_f32_32x32x16_bf16 v[0:15], v[128:131], v[80:83], v[0:15]
    v_mfma_f32_32x32x16_bf16 v[16:31], v[132:135], v[80:83], v[16:31]
    v_mfma_f32_32x32x16_bf16 v[32:47], v[128:131], v[84:87], v[32:47]
    v_mfma_f32_32x32x16_bf16 v[48:63], v[132:135], v[84:87], v[48:63]
    s_waitcnt vmcnt(6) lgkmcnt(0)
    v_mfma_f32_32x32x16_bf16 v[0:15], v[136:139], v[88:91], v[0:15]
    v_mfma_f32_32x32x16_bf16 v[16:31], v[140:143], v[88:91], v[16:31]
    v_mfma_f32_32x32x16_bf16 v[32:47], v[136:139], v[92:95], v[32:47]
    v_mfma_f32_32x32x16_bf16 v[48:63], v[140:143], v[92:95], v[48:63]
    s_waitcnt vmcnt(0)
    s_nop 7
    v_add_u32 v240, s1, v250
    s_mov_b32 s89, 1048576
    s_nop 1
    ds_write_b128 v240, v[32:35] offset:0
    ds_write_b128 v240, v[36:39] offset:1024
    ds_write_b128 v240, v[40:43] offset:2048
    ds_write_b128 v240, v[44:47] offset:3072
    ds_write_b128 v240, v[48:51] offset:20480
    ds_write_b128 v240, v[52:55] offset:21504
    ds_write_b128 v240, v[56:59] offset:22528
    ds_write_b128 v240, v[60:63] offset:23552
    s_waitcnt lgkmcnt(0)
    s_barrier
    buffer_load_dwordx4 v[64:67], v250, s[52:55], s76 offen offset:0 sc1
    buffer_load_dwordx4 v[68:71], v250, s[52:55], s76 offen offset:1024 sc1
    buffer_load_dwordx4 v[72:75], v250, s[52:55], s76 offen offset:2048 sc1
    buffer_load_dwordx4 v[76:79], v250, s[52:55], s76 offen offset:3072 sc1
    buffer_load_dwordx4 v[80:83], v250, s[52:55], s78 offen offset:0 sc1
    buffer_load_dwordx4 v[84:87], v250, s[52:55], s78 offen offset:1024 sc1
    buffer_load_dwordx4 v[88:91], v250, s[52:55], s78 offen offset:2048 sc1
    buffer_load_dwordx4 v[92:95], v250, s[52:55], s78 offen offset:3072 sc1
Lo_sent:
    ds_read_b64_tr_b16 v[128:129], v244 offset:0
    ds_read_b64_tr_b16 v[130:131], v244 offset:512
    ds_read_b64_tr_b16 v[132:133], v245 offset:0
    ds_read_b64_tr_b16 v[134:135], v245 offset:512
    ds_read_b64_tr_b16 v[136:137], v246 offset:1792
    ds_read_b64_tr_b16 v[138:139], v246 offset:2304
    ds_read_b64_tr_b16 v[140:141], v247 offset:1792
    ds_read_b64_tr_b16 v[142:143], v247 offset:2304
    s_waitcnt lgkmcnt(4)
    ds_read_b64_tr_b16 v[144:145], v244 offset:3584
    ds_read_b64_tr_b16 v[146:147], v244 offset:4096
    ds_read_b64_tr_b16 v[148:149], v245 offset:3584
    ds_read_b64_tr_b16 v[150:151], v245 offset:4096
    ds_read_b64_tr_b16 v[152:153], v246 offset:5376
    ds_read_b64_tr_b16 v[154:155], v246 offset:5888
    ds_read_b64_tr_b16 v[156:157], v247 offset:5376
    ds_read_b64_tr_b16 v[158:159], v247 offset:5888
    s_waitcnt lgkmcnt(4)
    ds_read_b64_tr_b16 v[160:161], v244 offset:7168
    ds_read_b64_tr_b16 v[162:163], v244 offset:7680
    ds_read_b64_tr_b16 v[164:165], v245 offset:7168
    ds_read_b64_tr_b16 v[166:167], v245 offset:7680
    ds_read_b64_tr_b16 v[168:169], v246 offset:8960
    ds_read_b64_tr_b16 v[170:171], v246 offset:9472
    ds_read_b64_tr_b16 v[172:173], v247 offset:8960
    ds_read_b64_tr_b16 v[174:175], v247 offset:9472
    s_waitcnt lgkmcnt(4)
    ds_read_b64_tr_b16 v[176:177], v244 offset:10752
    ds_read_b64_tr_b16 v[178:179], v244 offset:11264
    ds_read_b64_tr_b16 v[180:181], v245 offset:10752
    ds_read_b64_tr_b16 v[182:183], v245 offset:11264
    ds_read_b64_tr_b16 v[184:185], v246 offset:12544
    ds_read_b64_tr_b16 v[186:187], v246 offset:13056
    ds_read_b64_tr_b16 v[188:189], v247 offset:12544
    ds_read_b64_tr_b16 v[190:191], v247 offset:13056
    s_branch Lo_wait
Ltail:
    s_and_b32 s12, s3, 3
    s_lshl_b32 s11, s8, 1
    s_add_u32 s14, s11, s86
    s_lshl_b32 s11, s14, 2
    s_add_u32 s11, s11, s12
    s_lshl_b32 s13, s11, 13
    s_add_u32 s76, s13, 0xd00000
    s_add_u32 s78, s76, 4096
    s_mul_i32 s13, s12, 26624
    s_add_u32 s13, s13, 53248
    v_bfe_u32 v240, v251, 2, 2
    v_lshrrev_b32 v241, 5, v251
    v_mad_u32_u24 v240, v241, 7, v240
    v_lshl_add_u32 v241, v240, 7, s13
    v_bfe_u32 v240, v240, 1, 1
    v_lshlrev_b32 v240, 6, v240
    v_bfe_u32 v242, v251, 4, 1
    v_add_u32 v242, s12, v242
    v_and_b32 v243, 3, v251
    v_lshlrev_b32 v243, 3, v243
    v_add_u32 v239, 0, v242
    v_and_b32 v239, 3, v239
    v_lshl_add_u32 v239, v239, 5, v243
    v_xor_b32 v239, v239, v240
    v_add_u32 v244, v239, v241
    v_xor_b32 v239, 64, v239
    v_add_u32 v246, v239, v241
    v_add_u32 v239, 2, v242
    v_and_b32 v239, 3, v239
    v_lshl_add_u32 v239, v239, 5, v243
    v_xor_b32 v239, v239, v240
    v_add_u32 v245, v239, v241
    v_xor_b32 v239, 64, v239
    v_add_u32 v247, v239, v241
    s_sub_u32 s11, s12, 0
    s_and_b32 s11, s11, 3
    s_lshr_b32 s13, s11, 1
    s_mul_i32 s13, s13, 20480
    s_and_b32 s11, s11, 1
    s_lshl_b32 s11, s11, 11
    s_add_u32 s11, s11, s13
    s_add_u32 s11, s11, 49152
    v_add_u32 v236, s11, v250
    s_sub_u32 s11, s12, 1
    s_and_b32 s11, s11, 3
    s_lshr_b32 s13, s11, 1
    s_mul_i32 s13, s13, 20480
    s_and_b32 s11, s11, 1
    s_lshl_b32 s11, s11, 11
    s_add_u32 s11, s11, s13
    s_add_u32 s11, s11, 75776
    v_add_u32 v237, s11, v250
    s_sub_u32 s11, s12, 2
    s_and_b32 s11, s11, 3
    s_lshr_b32 s13, s11, 1
    s_mul_i32 s13, s13, 20480
    s_and_b32 s11, s11, 1
    s_lshl_b32 s11, s11, 11
    s_add_u32 s11, s11, s13
    s_add_u32 s11, s11, 102400
    v_add_u32 v238, s11, v250
    s_sub_u32 s11, s12, 3
    s_and_b32 s11, s11, 3
    s_lshr_b32 s13, s11, 1
    s_mul_i32 s13, s13, 20480
    s_and_b32 s11, s11, 1
    s_lshl_b32 s11, s11, 11
    s_add_u32 s11, s11, s13
    s_add_u32 s11, s11, 129024
    v_add_u32 v239, s11, v250
    s_mov_b32 s64, s32
    s_mov_b32 s65, s33
    s_mov_b32 s66, 0x1c0000
    s_mov_b32 s67, 0x20000
    v_and_b32 v240, 31, v251
    s_lshl_b32 s14, s14, 5
    v_add_u32 v240, s14, v240
    v_mul_u32_u24 v240, 896, v240
    v_lshrrev_b32 v243, 5, v251
    v_lshlrev_b32 v243, 4, v243
    s_lshl_b32 s13, s9, 7
    s_lshl_b32 s14, s12, 5
    s_add_u32 s13, s13, s14
    v_add3_u32 v249, v240, v243, s13
    s_mul_i32 s15, s86, 24576
    s_add_u32 s11, s12, 1
    s_and_b32 s11, s11, 3
    s_mul_i32 s11, s11, 6144
    s_add_u32 s11, s11, s15
    s_add_u32 s11, s11, 0
    v_add_u32 v233, s11, v250
    s_add_u32 s11, s12, 2
    s_and_b32 s11, s11, 3
    s_mul_i32 s11, s11, 6144
    s_add_u32 s11, s11, s15
    s_add_u32 s11, s11, 2048
    v_add_u32 v234, s11, v250
    s_add_u32 s11, s12, 3
    s_and_b32 s11, s11, 3
    s_mul_i32 s11, s11, 6144
    s_add_u32 s11, s11, s15
    s_add_u32 s11, s11, 4096
    v_add_u32 v235, s11, v250
    s_mul_i32 s11, s12, 6144
    s_add_u32 s11, s11, s15
    v_add_u32 v232, s11, v250
    s_and_b32 s15, s10, 0xffff0000
    s_mov_b32 s89, 1048576
    s_barrier
    buffer_load_dwordx4 v[64:67], v250, s[52:55], s76 offen offset:0 sc1
    buffer_load_dwordx4 v[68:71], v250, s[52:55], s76 offen offset:1024 sc1
    buffer_load_dwordx4 v[72:75], v250, s[52:55], s76 offen offset:2048 sc1
    buffer_load_dwordx4 v[76:79], v250, s[52:55], s76 offen offset:3072 sc1
    buffer_load_dwordx4 v[80:83], v250, s[52:55], s78 offen offset:0 sc1
    buffer_load_dwordx4 v[84:87], v250, s[52:55], s78 offen offset:1024 sc1
    buffer_load_dwordx4 v[88:91], v250, s[52:55], s78 offen offset:2048 sc1
    buffer_load_dwordx4 v[92:95], v250, s[52:55], s78 offen offset:3072 sc1
La_sent:
    ds_read_b64_tr_b16 v[128:129], v244 offset:0
    ds_read_b64_tr_b16 v[130:131], v244 offset:512
    ds_read_b64_tr_b16 v[132:133], v245 offset:0
    ds_read_b64_tr_b16 v[134:135], v245 offset:512
    ds_read_b64_tr_b16 v[136:137], v246 offset:1792
    ds_read_b64_tr_b16 v[138:139], v246 offset:2304
    ds_read_b64_tr_b16 v[140:141], v247 offset:1792
    ds_read_b64_tr_b16 v[142:143], v247 offset:2304
    s_waitcnt lgkmcnt(4)
    ds_read_b64_tr_b16 v[144:145], v244 offset:3584
    ds_read_b64_tr_b16 v[146:147], v244 offset:4096
    ds_read_b64_tr_b16 v[148:149], v245 offset:3584
    ds_read_b64_tr_b16 v[150:151], v245 offset:4096
    ds_read_b64_tr_b16 v[152:153], v246 offset:5376
    ds_read_b64_tr_b16 v[154:155], v246 offset:5888
    ds_read_b64_tr_b16 v[156:157], v247 offset:5376
    ds_read_b64_tr_b16 v[158:159], v247 offset:5888
    s_waitcnt lgkmcnt(4)
    ds_read_b64_tr_b16 v[160:161], v244 offset:7168
    ds_read_b64_tr_b16 v[162:163], v244 offset:7680
    ds_read_b64_tr_b16 v[164:165], v245 offset:7168
    ds_read_b64_tr_b16 v[166:167], v245 offset:7680
    ds_read_b64_tr_b16 v[168:169], v246 offset:8960
    ds_read_b64_tr_b16 v[170:171], v246 offset:9472
    ds_read_b64_tr_b16 v[172:173], v247 offset:8960
    ds_read_b64_tr_b16 v[174:175], v247 offset:9472
    s_waitcnt lgkmcnt(4)
    ds_read_b64_tr_b16 v[176:177], v244 offset:10752
    ds_read_b64_tr_b16 v[178:179], v244 offset:11264
    ds_read_b64_tr_b16 v[180:181], v245 offset:10752
    ds_read_b64_tr_b16 v[182:183], v245 offset:11264
    ds_read_b64_tr_b16 v[184:185], v246 offset:12544
    ds_read_b64_tr_b16 v[186:187], v246 offset:13056
    ds_read_b64_tr_b16 v[188:189], v247 offset:12544
    ds_read_b64_tr_b16 v[190:191], v247 offset:13056
    s_waitcnt lgkmcnt(0)
    ds_read_b128 v[0:3], v236 offset:0
    ds_read_b128 v[4:7], v236 offset:1024
    ds_read_b128 v[104:107], v237 offset:0
    ds_read_b128 v[108:111], v237 offset:1024
    ds_read_b128 v[112:115], v238 offset:0
    ds_read_b128 v[116:119], v238 offset:1024
    ds_read_b128 v[120:123], v239 offset:0
    ds_read_b128 v[124:127], v239 offset:1024
    v_mov_b32 v8, 0
    v_mov_b32 v9, 0
    v_mov_b32 v10, 0
    v_mov_b32 v11, 0
    v_mov_b32 v12, 0
    v_mov_b32 v13, 0
    v_mov_b32 v14, 0
    v_mov_b32 v15, 0
    v_mov_b32 v16, 0
    v_mov_b32 v17, 0
    v_mov_b32 v18, 0
    v_mov_b32 v19, 0
    v_mov_b32 v20, 0
    v_mov_b32 v21, 0
    v_mov_b32 v22, 0
    v_mov_b32 v23, 0
    v_mov_b32 v24, 0
    v_mov_b32 v25, 0
    v_mov_b32 v26, 0
    v_mov_b32 v27, 0
    v_mov_b32 v28, 0
    v_mov_b32 v29, 0
    v_mov_b32 v30, 0
    v_mov_b32 v31, 0
    s_waitcnt lgkmcnt(0)
    v_pk_add_f32 v[0:1], v[0:1], v[104:105]
    v_pk_add_f32 v[2:3], v[2:3], v[106:107]
    v_pk_add_f32 v[4:5], v[4:5], v[108:109]
    v_pk_add_f32 v[6:7], v[6:7], v[110:111]
    v_pk_add_f32 v[0:1], v[0:1], v[112:113]
    v_pk_add_f32 v[2:3], v[2:3], v[114:115]
    v_pk_add_f32 v[4:5], v[4:5], v[116:117]
    v_pk_add_f32 v[6:7], v[6:7], v[118:119]
    v_pk_add_f32 v[0:1], v[0:1], v[120:121]
    v_pk_add_f32 v[2:3], v[2:3], v[122:123]
    v_pk_add_f32 v[4:5], v[4:5], v[124:125]
    v_pk_add_f32 v[6:7], v[6:7], v[126:127]
Lo_wait:
    s_waitcnt vmcnt(0)
    v_xor_b32 v240, s15, v67
    v_xor_b32 v244, s15, v71
    v_xor_b32 v241, s15, v75
    v_xor_b32 v245, s15, v79
    v_xor_b32 v242, s15, v83
    v_xor_b32 v246, s15, v87
    v_xor_b32 v243, s15, v91
    v_xor_b32 v247, s15, v95
    v_or_b32 v240, v240, v244
    v_or_b32 v241, v241, v245
    v_or_b32 v242, v242, v246
    v_or_b32 v243, v243, v247
    v_or3_b32 v244, v240, v241, v242
    v_or_b32 v244, v244, v243
    v_cmp_lt_u32 vcc, 0xffff, v244
    v_mov_b32 v245, 0xffff
    s_nop 0
    s_cbranch_vccnz Lo_again
Lo_all:
    v_and_b32 v67, 0xffff, v67
    v_and_b32 v71, 0xffff, v71
    v_and_b32 v75, 0xffff, v75
    v_and_b32 v79, 0xffff, v79
    v_and_b32 v83, 0xffff, v83
    v_and_b32 v87, 0xffff, v87
    v_and_b32 v91, 0xffff, v91
    v_and_b32 v95, 0xffff, v95
Lo_go:
    s_waitcnt lgkmcnt(0)
    v_mfma_f32_32x32x16_bf16 v[16:31], v[132:135], v[64:67], v[16:31]
    v_mfma_f32_32x32x16_bf16 v[16:31], v[140:143], v[68:71], v[16:31]
    v_mfma_f32_32x32x16_bf16 v[16:31], v[148:151], v[72:75], v[16:31]
    v_mfma_f32_32x32x16_bf16 v[16:31], v[156:159], v[76:79], v[16:31]
    v_mfma_f32_32x32x16_bf16 v[16:31], v[164:167], v[80:83], v[16:31]
    v_mfma_f32_32x32x16_bf16 v[16:31], v[172:175], v[84:87], v[16:31]
    v_mfma_f32_32x32x16_bf16 v[16:31], v[180:183], v[88:91], v[16:31]
    v_mfma_f32_32x32x16_bf16 v[16:31], v[188:191], v[92:95], v[16:31]
    v_mfma_f32_32x32x16_bf16 v[0:15], v[128:131], v[64:67], v[0:15]
    v_mfma_f32_32x32x16_bf16 v[0:15], v[136:139], v[68:71], v[0:15]
    v_mfma_f32_32x32x16_bf16 v[0:15], v[144:147], v[72:75], v[0:15]
    v_mfma_f32_32x32x16_bf16 v[0:15], v[152:155], v[76:79], v[0:15]
    s_nop 7
    ds_write_b128 v234, v[16:19] offset:0
    v_mfma_f32_32x32x16_bf16 v[0:15], v[160:163], v[80:83], v[0:15]
    ds_write_b128 v234, v[20:23] offset:1024
    v_mfma_f32_32x32x16_bf16 v[0:15], v[168:171], v[84:87], v[0:15]
    ds_write_b128 v235, v[24:27] offset:0
    v_mfma_f32_32x32x16_bf16 v[0:15], v[176:179], v[88:91], v[0:15]
    ds_write_b128 v235, v[28:31] offset:1024
    v_mfma_f32_32x32x16_bf16 v[0:15], v[184:187], v[92:95], v[0:15]
    s_nop 11
    ds_write_b128 v233, v[8:11] offset:0
    ds_write_b128 v233, v[12:15] offset:1024
    s_waitcnt lgkmcnt(0)
    s_barrier
    ds_read_b128 v[96:99], v232 offset:0
    ds_read_b128 v[100:103], v232 offset:1024
    ds_read_b128 v[104:107], v232 offset:2048
    ds_read_b128 v[108:111], v232 offset:3072
    ds_read_b128 v[112:115], v232 offset:4096
    ds_read_b128 v[116:119], v232 offset:5120
Lfin_sum:
    s_waitcnt lgkmcnt(0)
    v_pk_add_f32 v[0:1], v[0:1], v[96:97]
    v_pk_add_f32 v[2:3], v[2:3], v[98:99]
    v_pk_add_f32 v[4:5], v[4:5], v[100:101]
    v_pk_add_f32 v[6:7], v[6:7], v[102:103]
    v_pk_add_f32 v[0:1], v[0:1], v[104:105]
    v_pk_add_f32 v[2:3], v[2:3], v[106:107]
    v_pk_add_f32 v[4:5], v[4:5], v[108:109]
    v_pk_add_f32 v[6:7], v[6:7], v[110:111]
    v_pk_add_f32 v[0:1], v[0:1], v[112:113]
    v_pk_add_f32 v[2:3], v[2:3], v[114:115]
    v_pk_add_f32 v[4:5], v[4:5], v[116:117]
    v_pk_add_f32 v[6:7], v[6:7], v[118:119]
    v_cvt_pk_bf16_f32 v8, v0, v1
    v_cvt_pk_bf16_f32 v9, v2, v3
    v_cvt_pk_bf16_f32 v10, v4, v5
    v_cvt_pk_bf16_f32 v11, v6, v7
    s_nop 1
    v_permlane32_swap_b32 v8, v10
    v_permlane32_swap_b32 v9, v11
    buffer_store_dwordx4 v[8:11], v249, s[64:67], 0 offen
    s_branch Lexit
Lo_again:
    s_sub_u32 s89, s89, 1
    s_cbranch_scc1 Lo_all
    v_cmp_lt_u32 vcc, v245, v240
    s_nop 1
    s_cbranch_vccz Lo_have0
    buffer_load_dwordx4 v[64:67], v250, s[52:55], s76 offen offset:0 sc1
    buffer_load_dwordx4 v[68:71], v250, s[52:55], s76 offen offset:1024 sc1
Lo_have0:
    v_cmp_lt_u32 vcc, v245, v241
    s_nop 1
    s_cbranch_vccz Lo_have1
    buffer_load_dwordx4 v[72:75], v250, s[52:55], s76 offen offset:2048 sc1
    buffer_load_dwordx4 v[76:79], v250, s[52:55], s76 offen offset:3072 sc1
Lo_have1:
    v_cmp_lt_u32 vcc, v245, v242
    s_nop 1
    s_cbranch_vccz Lo_have2
    buffer_load_dwordx4 v[80:83], v250, s[52:55], s78 offen offset:0 sc1
    buffer_load_dwordx4 v[84:87], v250, s[52:55], s78 offen offset:1024 sc1
Lo_have2:
    v_cmp_lt_u32 vcc, v245, v243
    s_nop 1
    s_cbranch_vccz Lo_have3
    buffer_load_dwordx4 v[88:91], v250, s[52:55], s78 offen offset:2048 sc1
    buffer_load_dwordx4 v[92:95], v250, s[52:55], s78 offen offset:3072 sc1
Lo_have3:
    s_branch Lo_wait
Lexit:
Lend:
    s_endpgm
.section .rodata,"a"
.p2align 6
.amdhsa_kernel gated_mix__mha_block__glu_gated_geglu__prompt_kernel
  .amdhsa_next_free_vgpr 256
  .amdhsa_next_free_sgpr 102
  .amdhsa_accum_offset 256
  .amdhsa_group_segment_fixed_size 0
  .amdhsa_kernarg_size 88
  .amdhsa_user_sgpr_count 2
  .amdhsa_user_sgpr_kernarg_segment_ptr 1
  .amdhsa_system_sgpr_workgroup_id_x 1
.end_amdhsa_kernel
```
